```python
import torch

def _softmax(x, axis=-1):
    return torch.softmax(x, dim=axis)
def _gelu(x):
    return torch.nn.functional.gelu(x, approximate="tanh")
def _silu(x):
    return torch.nn.functional.silu(x)
def _sigmoid(x):
    return torch.sigmoid(x)
def _layernorm(x, axis=-1, eps=1e-5):
    m = x.mean(dim=axis, keepdim=True)
    v = x.var(dim=axis, keepdim=True, unbiased=False)
    return (x - m) / torch.sqrt(v + eps)
def _scatter_add(tgt, idx, src, axis=0):
    return tgt.clone().index_add_(axis, idx, src)
def _segment_sum(src, seg, n):
    out = torch.zeros((n,) + src.shape[1:], dtype=src.dtype)
    return out.index_add_(0, seg, src)
def _pad(x, pw):
    flat = tuple(v for pair in reversed(pw) for v in pair)
    return torch.nn.functional.pad(x, flat)

kernel_name = 'gated_mix__mha_block_cached__glu_gated_swiglu__decode'

def setup_inputs():

    _w = (lambda a: (lambda t: t.to(torch.bfloat16) if t.is_floating_point() else t)(torch.as_tensor(a)))
    def _A_setup():
        B, Sq, D = 4, 1, 512
        H, Sk, Dh = 32, 8192, 128
        return {
            "x": _w((lambda *s: torch.randn(*s, dtype=torch.bfloat16) * 0.05)(B, Sq, D)),
            "k_cache": _w((lambda *s: torch.randn(*s, dtype=torch.bfloat16) * 6.4)(B, H, Sk, Dh)),
            "v_cache": _w((lambda *s: torch.randn(*s, dtype=torch.bfloat16) * 0.2)(B, H, Sk, Dh)),
            "wq": _w((lambda *s: torch.randn(*s, dtype=torch.bfloat16) * 6.4)(D, H * Dh) * (D ** -0.5)),
            "wo": _w((lambda *s: torch.randn(*s, dtype=torch.bfloat16) * 0.2)(H * Dh, D) * ((H * Dh) ** -0.5)),
        }
    _A_in = _A_setup()

    def _B_setup():
        B, S, D, F = 4, 1, 512, 1792
        return {
            "x": _w((lambda *s: torch.randn(*s, dtype=torch.bfloat16) * 0.05)(B, S, D)),
            "w1": _w((lambda *s: torch.randn(*s, dtype=torch.bfloat16) * 0.8)(D, F) * (2.0 / D) ** 0.5),
            "w3": _w((lambda *s: torch.randn(*s, dtype=torch.bfloat16) * 0.8)(D, F) * (2.0 / D) ** 0.5),
            "w2": _w((lambda *s: torch.randn(*s, dtype=torch.bfloat16) * 0.8)(F, D) * (2.0 / F) ** 0.5),
        }
    _B_in = _B_setup()

    return {
        "A_x": _A_in["x"],
        "A_k_cache": _A_in["k_cache"],
        "A_v_cache": _A_in["v_cache"],
        "A_wq": _A_in["wq"],
        "A_wo": _A_in["wo"],
        "B_x": _B_in["x"],
        "B_w1": _B_in["w1"],
        "B_w3": _B_in["w3"],
        "B_w2": _B_in["w2"],
        "gate_w": _w((lambda *s: torch.randn(*s, dtype=torch.bfloat16) * 0.05)(512) * 16.0),
    }

def reference(A_x, A_k_cache, A_v_cache, A_wq, A_wo, B_x, B_w1, B_w3, B_w2, gate_w):
    def _A_ref(x, k_cache, v_cache, wq, wo):
        B, Sq, D = x.shape
        H, Dh = 32, 128
        q = (lambda x, *d: x.permute(*d))((x @ wq).reshape(B, Sq, H, Dh), 0, 2, 1, 3)
        scores = torch.einsum("bhqd,bhkd->bhqk", q, k_cache) * (Dh ** -0.5)
        p = _softmax(scores, axis=-1)
        o = torch.einsum("bhqk,bhkd->bhqd", p, v_cache)
        return (lambda x, *d: x.permute(*d))(o, 0, 2, 1, 3).reshape(B, Sq, H * Dh) @ wo

    def _B_ref(x, w1, w3, w2):
        gate = torch.einsum("bsd,df->bsf", x, w1)
        up = torch.einsum("bsd,df->bsf", x, w3)
        h = _silu(gate) * up
        out = torch.einsum("bsf,fd->bsd", h, w2)
        return out

    x = A_x
    g = _sigmoid((x * gate_w).sum(-1, keepdims=True))
    a = _A_ref(x, A_k_cache, A_v_cache, A_wq, A_wo)
    b = _B_ref(x, B_w1, B_w3, B_w2)
    return g * a + (1 - g) * b
```

```asm
; @launch grid=(256,1,1) block=(576,1,1) lds=28800
.amdgcn_target "amdgcn-amd-amdhsa--gfx950"
.text
.globl gated_mix__mha_block_cached__glu_gated_swiglu__decode_kernel
.p2align 8
.type gated_mix__mha_block_cached__glu_gated_swiglu__decode_kernel,@function
gated_mix__mha_block_cached__glu_gated_swiglu__decode_kernel:
    s_cmp_ge_u32 s2, 256
    s_cbranch_scc1 L_end
    s_load_dwordx16 s[4:19], s[0:1], 0
    s_load_dwordx8 s[20:27], s[0:1], 64
    s_load_dwordx2 s[28:29], s[0:1], 96
    v_lshrrev_b32 v1, 6, v0
    v_and_b32 v0, 63, v0
    v_readfirstlane_b32 s80, v1
    s_bfe_u32 s81, s2, 0x30003
    s_and_b32 s83, s2, 1
    s_lshl_b32 s3, s81, 1
    s_lshr_b32 s3, 0xc9a5, s3
    s_mul_i32 s3, s3, s83
    s_lshr_b32 s82, s2, 1
    s_xor_b32 s3, s3, s82
    s_and_b32 s3, s3, 3
    s_lshl_b32 s3, s3, 3
    s_add_u32 s81, s81, s3
    s_lshr_b32 s82, s2, 6
    s_lshl_b32 s89, s82, 5
    s_add_u32 s89, s89, s81
    s_lshl_b32 s97, s89, 21
    s_lshl_b32 s3, s89, 8
    s_add_u32 s3, s3, 0x90000
    v_lshlrev_b32 v1, 4, v0
    v_and_b32 v161, 15, v0
    v_lshrrev_b32 v162, 4, v0
    s_cmp_eq_u32 s80, 8
    s_cbranch_scc1 L_ffn
    s_setprio 3
    s_lshl_b32 s89, s83, 3
    s_add_u32 s89, s89, s80
    s_lshl_b32 s89, s89, 14
    s_add_u32 s84, s97, s89
    s_add_u32 s85, s84, 4096
    s_add_u32 s86, s84, 8192
    s_add_u32 s87, s84, 12288
    v_lshlrev_b32 v6, 13, v162
    v_lshl_add_u32 v6, v161, 4, v6
    s_lshl_b32 s89, s80, 19
    s_lshl_b32 s91, s81, 8
    s_add_u32 s89, s89, s91
    s_lshl_b32 s91, s82, 2
    v_add_u32 v7, s91, v161
    v_and_b32 v7, 15, v7
    v_lshl_add_u32 v7, v7, 2, v162
    v_lshlrev_b32 v7, 1, v7
    s_lshl_b32 s91, s82, 10
    s_lshl_b32 s96, s80, 7
    s_add_u32 s91, s91, s96
    s_lshl_b32 s88, s82, 17
    s_waitcnt lgkmcnt(0)
    s_mov_b32 s48, s4
    s_mov_b32 s49, s5
    s_mov_b32 s50, 0x1000
    s_mov_b32 s51, 0x00020000
    s_mov_b32 s40, s10
    s_mov_b32 s41, s11
    s_mov_b32 s42, 0x400000
    s_mov_b32 s43, 0x00020000
    buffer_load_ushort v4, v7, s[48:51], s91 offen
    s_add_u32 s96, s89, s88
    buffer_load_dwordx4 v[96:99], v6, s[40:43], s96 offen
    s_add_u32 s88, s88, 32768
    s_and_b32 s88, s88, 0x7ffff
    s_add_u32 s96, s89, s88
    buffer_load_dwordx4 v[100:103], v6, s[40:43], s96 offen
    s_add_u32 s88, s88, 32768
    s_and_b32 s88, s88, 0x7ffff
    s_add_u32 s96, s89, s88
    buffer_load_dwordx4 v[104:107], v6, s[40:43], s96 offen
    s_add_u32 s88, s88, 32768
    s_and_b32 s88, s88, 0x7ffff
    s_add_u32 s96, s89, s88
    buffer_load_dwordx4 v[108:111], v6, s[40:43], s96 offen
    s_add_u32 s88, s88, 32768
    s_and_b32 s88, s88, 0x7ffff
    s_mov_b32 s32, s6
    s_mov_b32 s33, s7
    s_mov_b32 s34, 0x10000000
    s_mov_b32 s35, 0x00020000
    s_setprio 2
    buffer_load_dwordx4 v[32:35], v1, s[32:35], s84 offen offset:0 nt
    buffer_load_dwordx4 v[36:39], v1, s[32:35], s84 offen offset:1024 nt
    buffer_load_dwordx4 v[40:43], v1, s[32:35], s84 offen offset:2048 nt
    buffer_load_dwordx4 v[44:47], v1, s[32:35], s84 offen offset:3072 nt
    buffer_load_dwordx4 v[48:51], v1, s[32:35], s85 offen offset:0 nt
    buffer_load_dwordx4 v[52:55], v1, s[32:35], s85 offen offset:1024 nt
    buffer_load_dwordx4 v[56:59], v1, s[32:35], s85 offen offset:2048 nt
    buffer_load_dwordx4 v[60:63], v1, s[32:35], s85 offen offset:3072 nt
    buffer_load_dwordx4 v[64:67], v1, s[32:35], s86 offen offset:0 nt
    buffer_load_dwordx4 v[68:71], v1, s[32:35], s86 offen offset:1024 nt
    buffer_load_dwordx4 v[72:75], v1, s[32:35], s86 offen offset:2048 nt
    buffer_load_dwordx4 v[76:79], v1, s[32:35], s86 offen offset:3072 nt
    buffer_load_dwordx4 v[80:83], v1, s[32:35], s87 offen offset:0 nt
    buffer_load_dwordx4 v[84:87], v1, s[32:35], s87 offen offset:1024 nt
    buffer_load_dwordx4 v[88:91], v1, s[32:35], s87 offen offset:2048 nt
    buffer_load_dwordx4 v[92:95], v1, s[32:35], s87 offen offset:3072 nt
    s_setprio 1
    s_add_u32 s96, s89, s88
    buffer_load_dwordx4 v[112:115], v6, s[40:43], s96 offen
    s_add_u32 s88, s88, 32768
    s_and_b32 s88, s88, 0x7ffff
    s_add_u32 s96, s89, s88
    buffer_load_dwordx4 v[116:119], v6, s[40:43], s96 offen
    s_add_u32 s88, s88, 32768
    s_and_b32 s88, s88, 0x7ffff
    s_add_u32 s96, s89, s88
    buffer_load_dwordx4 v[120:123], v6, s[40:43], s96 offen
    s_add_u32 s88, s88, 32768
    s_and_b32 s88, s88, 0x7ffff
    s_add_u32 s96, s89, s88
    buffer_load_dwordx4 v[124:127], v6, s[40:43], s96 offen
    s_add_u32 s88, s88, 32768
    s_and_b32 s88, s88, 0x7ffff
    s_add_u32 s96, s89, s88
    buffer_load_dwordx4 v[128:131], v6, s[40:43], s96 offen
    s_add_u32 s88, s88, 32768
    s_and_b32 s88, s88, 0x7ffff
    s_add_u32 s96, s89, s88
    buffer_load_dwordx4 v[132:135], v6, s[40:43], s96 offen
    s_add_u32 s88, s88, 32768
    s_and_b32 s88, s88, 0x7ffff
    s_add_u32 s96, s89, s88
    buffer_load_dwordx4 v[136:139], v6, s[40:43], s96 offen
    s_add_u32 s88, s88, 32768
    s_and_b32 s88, s88, 0x7ffff
    s_add_u32 s96, s89, s88
    buffer_load_dwordx4 v[140:143], v6, s[40:43], s96 offen
    s_add_u32 s88, s88, 32768
    s_and_b32 s88, s88, 0x7ffff
    s_add_u32 s96, s89, s88
    buffer_load_dwordx4 v[144:147], v6, s[40:43], s96 offen
    s_add_u32 s88, s88, 32768
    s_and_b32 s88, s88, 0x7ffff
    s_add_u32 s96, s89, s88
    buffer_load_dwordx4 v[148:151], v6, s[40:43], s96 offen
    s_add_u32 s88, s88, 32768
    s_and_b32 s88, s88, 0x7ffff
    s_add_u32 s96, s89, s88
    buffer_load_dwordx4 v[152:155], v6, s[40:43], s96 offen
    s_add_u32 s88, s88, 32768
    s_and_b32 s88, s88, 0x7ffff
    s_add_u32 s96, s89, s88
    buffer_load_dwordx4 v[156:159], v6, s[40:43], s96 offen
    s_setprio 0
    s_mov_b32 s36, s8
    s_mov_b32 s37, s9
    s_mov_b32 s38, 0x10000000
    s_mov_b32 s39, 0x00020000
    s_mov_b32 s44, s12
    s_mov_b32 s45, s13
    s_mov_b32 s46, 0x400000
    s_mov_b32 s47, 0x00020000
    s_mov_b32 s68, s24
    s_mov_b32 s69, s25
    s_mov_b32 s70, 0x1000
    s_mov_b32 s71, 0x00020000
    s_mov_b32 s72, s26
    s_mov_b32 s73, s27
    s_mov_b32 s74, 0x100
    s_mov_b32 s75, 0x00020000
    s_mov_b32 s76, s28
    s_mov_b32 s77, s29
    s_mov_b32 s78, 0x100000
    s_mov_b32 s79, 0x00020000
    s_mov_b32 s90, 0x3e0293ee
    s_mov_b32 s92, 0xcccccccc
    s_mov_b32 s93, 0xcccccccc
    s_mov_b32 s94, 0xaaaaaaaa
    s_mov_b32 s95, 0xaaaaaaaa
    v_mov_b32 v8, 0
    v_mov_b32 v9, 0
    v_mov_b32 v10, 0
    v_mov_b32 v11, 0
    v_mov_b32 v12, 0
    v_mov_b32 v13, 0
    v_mov_b32 v14, 0
    v_mov_b32 v15, 0
    v_lshlrev_b32 v160, 5, v161
    v_lshl_add_u32 v160, v162, 3, v160
    s_lshl_b32 s89, s80, 9
    v_add_u32 v160, s89, v160
    v_mov_b32 v2, 0xf149f2ca
    v_mov_b32 v3, 0
    s_waitcnt vmcnt(32)
    v_lshlrev_b32 v5, 16, v4
    s_nop 1
    s_waitcnt vmcnt(31)
    v_dot2c_f32_bf16_dpp v8, v4, v96 row_newbcast:0 row_mask:0xf bank_mask:0xf
    v_dot2c_f32_bf16_dpp v9, v5, v96 row_newbcast:0 row_mask:0xf bank_mask:0xf
    v_dot2c_f32_bf16_dpp v10, v4, v97 row_newbcast:0 row_mask:0xf bank_mask:0xf
    v_dot2c_f32_bf16_dpp v11, v5, v97 row_newbcast:0 row_mask:0xf bank_mask:0xf
    v_dot2c_f32_bf16_dpp v12, v4, v98 row_newbcast:0 row_mask:0xf bank_mask:0xf
    v_dot2c_f32_bf16_dpp v13, v5, v98 row_newbcast:0 row_mask:0xf bank_mask:0xf
    v_dot2c_f32_bf16_dpp v14, v4, v99 row_newbcast:0 row_mask:0xf bank_mask:0xf
    v_dot2c_f32_bf16_dpp v15, v5, v99 row_newbcast:0 row_mask:0xf bank_mask:0xf
    buffer_load_dwordx4 v[96:99], v1, s[36:39], s84 offen offset:0 nt
    s_waitcnt vmcnt(31)
    v_dot2c_f32_bf16_dpp v8, v4, v100 row_newbcast:1 row_mask:0xf bank_mask:0xf
    v_dot2c_f32_bf16_dpp v9, v5, v100 row_newbcast:1 row_mask:0xf bank_mask:0xf
    v_dot2c_f32_bf16_dpp v10, v4, v101 row_newbcast:1 row_mask:0xf bank_mask:0xf
    v_dot2c_f32_bf16_dpp v11, v5, v101 row_newbcast:1 row_mask:0xf bank_mask:0xf
    v_dot2c_f32_bf16_dpp v12, v4, v102 row_newbcast:1 row_mask:0xf bank_mask:0xf
    v_dot2c_f32_bf16_dpp v13, v5, v102 row_newbcast:1 row_mask:0xf bank_mask:0xf
    v_dot2c_f32_bf16_dpp v14, v4, v103 row_newbcast:1 row_mask:0xf bank_mask:0xf
    v_dot2c_f32_bf16_dpp v15, v5, v103 row_newbcast:1 row_mask:0xf bank_mask:0xf
    buffer_load_dwordx4 v[100:103], v1, s[36:39], s84 offen offset:1024 nt
    s_waitcnt vmcnt(31)
    v_dot2c_f32_bf16_dpp v8, v4, v104 row_newbcast:2 row_mask:0xf bank_mask:0xf
    v_dot2c_f32_bf16_dpp v9, v5, v104 row_newbcast:2 row_mask:0xf bank_mask:0xf
    v_dot2c_f32_bf16_dpp v10, v4, v105 row_newbcast:2 row_mask:0xf bank_mask:0xf
    v_dot2c_f32_bf16_dpp v11, v5, v105 row_newbcast:2 row_mask:0xf bank_mask:0xf
    v_dot2c_f32_bf16_dpp v12, v4, v106 row_newbcast:2 row_mask:0xf bank_mask:0xf
    v_dot2c_f32_bf16_dpp v13, v5, v106 row_newbcast:2 row_mask:0xf bank_mask:0xf
    v_dot2c_f32_bf16_dpp v14, v4, v107 row_newbcast:2 row_mask:0xf bank_mask:0xf
    v_dot2c_f32_bf16_dpp v15, v5, v107 row_newbcast:2 row_mask:0xf bank_mask:0xf
    buffer_load_dwordx4 v[104:107], v1, s[36:39], s84 offen offset:2048 nt
    s_waitcnt vmcnt(31)
    v_dot2c_f32_bf16_dpp v8, v4, v108 row_newbcast:3 row_mask:0xf bank_mask:0xf
    v_dot2c_f32_bf16_dpp v9, v5, v108 row_newbcast:3 row_mask:0xf bank_mask:0xf
    v_dot2c_f32_bf16_dpp v10, v4, v109 row_newbcast:3 row_mask:0xf bank_mask:0xf
    v_dot2c_f32_bf16_dpp v11, v5, v109 row_newbcast:3 row_mask:0xf bank_mask:0xf
    v_dot2c_f32_bf16_dpp v12, v4, v110 row_newbcast:3 row_mask:0xf bank_mask:0xf
    v_dot2c_f32_bf16_dpp v13, v5, v110 row_newbcast:3 row_mask:0xf bank_mask:0xf
    v_dot2c_f32_bf16_dpp v14, v4, v111 row_newbcast:3 row_mask:0xf bank_mask:0xf
    v_dot2c_f32_bf16_dpp v15, v5, v111 row_newbcast:3 row_mask:0xf bank_mask:0xf
    buffer_load_dwordx4 v[108:111], v1, s[36:39], s84 offen offset:3072 nt
    s_waitcnt vmcnt(15)
    v_dot2c_f32_bf16_dpp v8, v4, v112 row_newbcast:4 row_mask:0xf bank_mask:0xf
    v_dot2c_f32_bf16_dpp v9, v5, v112 row_newbcast:4 row_mask:0xf bank_mask:0xf
    v_dot2c_f32_bf16_dpp v10, v4, v113 row_newbcast:4 row_mask:0xf bank_mask:0xf
    v_dot2c_f32_bf16_dpp v11, v5, v113 row_newbcast:4 row_mask:0xf bank_mask:0xf
    v_dot2c_f32_bf16_dpp v12, v4, v114 row_newbcast:4 row_mask:0xf bank_mask:0xf
    v_dot2c_f32_bf16_dpp v13, v5, v114 row_newbcast:4 row_mask:0xf bank_mask:0xf
    v_dot2c_f32_bf16_dpp v14, v4, v115 row_newbcast:4 row_mask:0xf bank_mask:0xf
    v_dot2c_f32_bf16_dpp v15, v5, v115 row_newbcast:4 row_mask:0xf bank_mask:0xf
    s_waitcnt vmcnt(14)
    v_dot2c_f32_bf16_dpp v8, v4, v116 row_newbcast:5 row_mask:0xf bank_mask:0xf
    v_dot2c_f32_bf16_dpp v9, v5, v116 row_newbcast:5 row_mask:0xf bank_mask:0xf
    v_dot2c_f32_bf16_dpp v10, v4, v117 row_newbcast:5 row_mask:0xf bank_mask:0xf
    v_dot2c_f32_bf16_dpp v11, v5, v117 row_newbcast:5 row_mask:0xf bank_mask:0xf
    v_dot2c_f32_bf16_dpp v12, v4, v118 row_newbcast:5 row_mask:0xf bank_mask:0xf
    v_dot2c_f32_bf16_dpp v13, v5, v118 row_newbcast:5 row_mask:0xf bank_mask:0xf
    v_dot2c_f32_bf16_dpp v14, v4, v119 row_newbcast:5 row_mask:0xf bank_mask:0xf
    v_dot2c_f32_bf16_dpp v15, v5, v119 row_newbcast:5 row_mask:0xf bank_mask:0xf
    s_waitcnt vmcnt(13)
    v_dot2c_f32_bf16_dpp v8, v4, v120 row_newbcast:6 row_mask:0xf bank_mask:0xf
    v_dot2c_f32_bf16_dpp v9, v5, v120 row_newbcast:6 row_mask:0xf bank_mask:0xf
    v_dot2c_f32_bf16_dpp v10, v4, v121 row_newbcast:6 row_mask:0xf bank_mask:0xf
    v_dot2c_f32_bf16_dpp v11, v5, v121 row_newbcast:6 row_mask:0xf bank_mask:0xf
    v_dot2c_f32_bf16_dpp v12, v4, v122 row_newbcast:6 row_mask:0xf bank_mask:0xf
    v_dot2c_f32_bf16_dpp v13, v5, v122 row_newbcast:6 row_mask:0xf bank_mask:0xf
    v_dot2c_f32_bf16_dpp v14, v4, v123 row_newbcast:6 row_mask:0xf bank_mask:0xf
    v_dot2c_f32_bf16_dpp v15, v5, v123 row_newbcast:6 row_mask:0xf bank_mask:0xf
    s_waitcnt vmcnt(12)
    v_dot2c_f32_bf16_dpp v8, v4, v124 row_newbcast:7 row_mask:0xf bank_mask:0xf
    v_dot2c_f32_bf16_dpp v9, v5, v124 row_newbcast:7 row_mask:0xf bank_mask:0xf
    v_dot2c_f32_bf16_dpp v10, v4, v125 row_newbcast:7 row_mask:0xf bank_mask:0xf
    v_dot2c_f32_bf16_dpp v11, v5, v125 row_newbcast:7 row_mask:0xf bank_mask:0xf
    v_dot2c_f32_bf16_dpp v12, v4, v126 row_newbcast:7 row_mask:0xf bank_mask:0xf
    v_dot2c_f32_bf16_dpp v13, v5, v126 row_newbcast:7 row_mask:0xf bank_mask:0xf
    v_dot2c_f32_bf16_dpp v14, v4, v127 row_newbcast:7 row_mask:0xf bank_mask:0xf
    v_dot2c_f32_bf16_dpp v15, v5, v127 row_newbcast:7 row_mask:0xf bank_mask:0xf
    s_waitcnt vmcnt(11)
    v_dot2c_f32_bf16_dpp v8, v4, v128 row_newbcast:8 row_mask:0xf bank_mask:0xf
    v_dot2c_f32_bf16_dpp v9, v5, v128 row_newbcast:8 row_mask:0xf bank_mask:0xf
    v_dot2c_f32_bf16_dpp v10, v4, v129 row_newbcast:8 row_mask:0xf bank_mask:0xf
    v_dot2c_f32_bf16_dpp v11, v5, v129 row_newbcast:8 row_mask:0xf bank_mask:0xf
    v_dot2c_f32_bf16_dpp v12, v4, v130 row_newbcast:8 row_mask:0xf bank_mask:0xf
    v_dot2c_f32_bf16_dpp v13, v5, v130 row_newbcast:8 row_mask:0xf bank_mask:0xf
    v_dot2c_f32_bf16_dpp v14, v4, v131 row_newbcast:8 row_mask:0xf bank_mask:0xf
    v_dot2c_f32_bf16_dpp v15, v5, v131 row_newbcast:8 row_mask:0xf bank_mask:0xf
    s_waitcnt vmcnt(10)
    v_dot2c_f32_bf16_dpp v8, v4, v132 row_newbcast:9 row_mask:0xf bank_mask:0xf
    v_dot2c_f32_bf16_dpp v9, v5, v132 row_newbcast:9 row_mask:0xf bank_mask:0xf
    v_dot2c_f32_bf16_dpp v10, v4, v133 row_newbcast:9 row_mask:0xf bank_mask:0xf
    v_dot2c_f32_bf16_dpp v11, v5, v133 row_newbcast:9 row_mask:0xf bank_mask:0xf
    v_dot2c_f32_bf16_dpp v12, v4, v134 row_newbcast:9 row_mask:0xf bank_mask:0xf
    v_dot2c_f32_bf16_dpp v13, v5, v134 row_newbcast:9 row_mask:0xf bank_mask:0xf
    v_dot2c_f32_bf16_dpp v14, v4, v135 row_newbcast:9 row_mask:0xf bank_mask:0xf
    v_dot2c_f32_bf16_dpp v15, v5, v135 row_newbcast:9 row_mask:0xf bank_mask:0xf
    s_waitcnt vmcnt(9)
    v_dot2c_f32_bf16_dpp v8, v4, v136 row_newbcast:10 row_mask:0xf bank_mask:0xf
    v_dot2c_f32_bf16_dpp v9, v5, v136 row_newbcast:10 row_mask:0xf bank_mask:0xf
    v_dot2c_f32_bf16_dpp v10, v4, v137 row_newbcast:10 row_mask:0xf bank_mask:0xf
    v_dot2c_f32_bf16_dpp v11, v5, v137 row_newbcast:10 row_mask:0xf bank_mask:0xf
    v_dot2c_f32_bf16_dpp v12, v4, v138 row_newbcast:10 row_mask:0xf bank_mask:0xf
    v_dot2c_f32_bf16_dpp v13, v5, v138 row_newbcast:10 row_mask:0xf bank_mask:0xf
    v_dot2c_f32_bf16_dpp v14, v4, v139 row_newbcast:10 row_mask:0xf bank_mask:0xf
    v_dot2c_f32_bf16_dpp v15, v5, v139 row_newbcast:10 row_mask:0xf bank_mask:0xf
    s_waitcnt vmcnt(8)
    v_dot2c_f32_bf16_dpp v8, v4, v140 row_newbcast:11 row_mask:0xf bank_mask:0xf
    v_dot2c_f32_bf16_dpp v9, v5, v140 row_newbcast:11 row_mask:0xf bank_mask:0xf
    v_dot2c_f32_bf16_dpp v10, v4, v141 row_newbcast:11 row_mask:0xf bank_mask:0xf
    v_dot2c_f32_bf16_dpp v11, v5, v141 row_newbcast:11 row_mask:0xf bank_mask:0xf
    v_dot2c_f32_bf16_dpp v12, v4, v142 row_newbcast:11 row_mask:0xf bank_mask:0xf
    v_dot2c_f32_bf16_dpp v13, v5, v142 row_newbcast:11 row_mask:0xf bank_mask:0xf
    v_dot2c_f32_bf16_dpp v14, v4, v143 row_newbcast:11 row_mask:0xf bank_mask:0xf
    v_dot2c_f32_bf16_dpp v15, v5, v143 row_newbcast:11 row_mask:0xf bank_mask:0xf
    s_waitcnt vmcnt(7)
    v_dot2c_f32_bf16_dpp v8, v4, v144 row_newbcast:12 row_mask:0xf bank_mask:0xf
    v_dot2c_f32_bf16_dpp v9, v5, v144 row_newbcast:12 row_mask:0xf bank_mask:0xf
    v_dot2c_f32_bf16_dpp v10, v4, v145 row_newbcast:12 row_mask:0xf bank_mask:0xf
    v_dot2c_f32_bf16_dpp v11, v5, v145 row_newbcast:12 row_mask:0xf bank_mask:0xf
    v_dot2c_f32_bf16_dpp v12, v4, v146 row_newbcast:12 row_mask:0xf bank_mask:0xf
    v_dot2c_f32_bf16_dpp v13, v5, v146 row_newbcast:12 row_mask:0xf bank_mask:0xf
    v_dot2c_f32_bf16_dpp v14, v4, v147 row_newbcast:12 row_mask:0xf bank_mask:0xf
    v_dot2c_f32_bf16_dpp v15, v5, v147 row_newbcast:12 row_mask:0xf bank_mask:0xf
    s_waitcnt vmcnt(6)
    v_dot2c_f32_bf16_dpp v8, v4, v148 row_newbcast:13 row_mask:0xf bank_mask:0xf
    v_dot2c_f32_bf16_dpp v9, v5, v148 row_newbcast:13 row_mask:0xf bank_mask:0xf
    v_dot2c_f32_bf16_dpp v10, v4, v149 row_newbcast:13 row_mask:0xf bank_mask:0xf
    v_dot2c_f32_bf16_dpp v11, v5, v149 row_newbcast:13 row_mask:0xf bank_mask:0xf
    v_dot2c_f32_bf16_dpp v12, v4, v150 row_newbcast:13 row_mask:0xf bank_mask:0xf
    v_dot2c_f32_bf16_dpp v13, v5, v150 row_newbcast:13 row_mask:0xf bank_mask:0xf
    v_dot2c_f32_bf16_dpp v14, v4, v151 row_newbcast:13 row_mask:0xf bank_mask:0xf
    v_dot2c_f32_bf16_dpp v15, v5, v151 row_newbcast:13 row_mask:0xf bank_mask:0xf
    s_waitcnt vmcnt(5)
    v_dot2c_f32_bf16_dpp v8, v4, v152 row_newbcast:14 row_mask:0xf bank_mask:0xf
    v_dot2c_f32_bf16_dpp v9, v5, v152 row_newbcast:14 row_mask:0xf bank_mask:0xf
    v_dot2c_f32_bf16_dpp v10, v4, v153 row_newbcast:14 row_mask:0xf bank_mask:0xf
    v_dot2c_f32_bf16_dpp v11, v5, v153 row_newbcast:14 row_mask:0xf bank_mask:0xf
    v_dot2c_f32_bf16_dpp v12, v4, v154 row_newbcast:14 row_mask:0xf bank_mask:0xf
    v_dot2c_f32_bf16_dpp v13, v5, v154 row_newbcast:14 row_mask:0xf bank_mask:0xf
    v_dot2c_f32_bf16_dpp v14, v4, v155 row_newbcast:14 row_mask:0xf bank_mask:0xf
    v_dot2c_f32_bf16_dpp v15, v5, v155 row_newbcast:14 row_mask:0xf bank_mask:0xf
    s_waitcnt vmcnt(4)
    v_dot2c_f32_bf16_dpp v8, v4, v156 row_newbcast:15 row_mask:0xf bank_mask:0xf
    v_dot2c_f32_bf16_dpp v9, v5, v156 row_newbcast:15 row_mask:0xf bank_mask:0xf
    v_dot2c_f32_bf16_dpp v10, v4, v157 row_newbcast:15 row_mask:0xf bank_mask:0xf
    v_dot2c_f32_bf16_dpp v11, v5, v157 row_newbcast:15 row_mask:0xf bank_mask:0xf
    v_dot2c_f32_bf16_dpp v12, v4, v158 row_newbcast:15 row_mask:0xf bank_mask:0xf
    v_dot2c_f32_bf16_dpp v13, v5, v158 row_newbcast:15 row_mask:0xf bank_mask:0xf
    v_dot2c_f32_bf16_dpp v14, v4, v159 row_newbcast:15 row_mask:0xf bank_mask:0xf
    v_dot2c_f32_bf16_dpp v15, v5, v159 row_newbcast:15 row_mask:0xf bank_mask:0xf
    s_nop 2
    v_permlane32_swap_b32 v8, v12
    v_permlane32_swap_b32 v9, v13
    v_permlane32_swap_b32 v10, v14
    v_permlane32_swap_b32 v11, v15
    v_add_f32 v8, v8, v12
    v_add_f32 v9, v9, v13
    v_add_f32 v10, v10, v14
    v_add_f32 v11, v11, v15
    s_nop 1
    v_permlane16_swap_b32 v8, v10
    v_permlane16_swap_b32 v9, v11
    v_add_f32 v8, v8, v10
    v_add_f32 v9, v9, v11
    ds_write_b64 v160, v[8:9] offset:0
    v_lshlrev_b32 v6, 3, v0
    s_waitcnt lgkmcnt(0)
    s_barrier
    ds_read_b64 v[8:9], v6 offset:0
    ds_read_b64 v[10:11], v6 offset:512
    ds_read_b64 v[12:13], v6 offset:1024
    ds_read_b64 v[14:15], v6 offset:1536
    ds_read_b64 v[20:21], v6 offset:2048
    ds_read_b64 v[22:23], v6 offset:2560
    ds_read_b64 v[24:25], v6 offset:3072
    ds_read_b64 v[26:27], v6 offset:3584
    s_lshl_b32 s89, s80, 8
    v_lshl_add_u32 v6, v0, 2, s89
    v_lshl_add_u32 v7, v161, 4, s89
    s_waitcnt lgkmcnt(0)
    v_add_f32 v8, v8, v20
    v_add_f32 v9, v9, v21
    v_add_f32 v10, v10, v22
    v_add_f32 v11, v11, v23
    v_add_f32 v12, v12, v24
    v_add_f32 v13, v13, v25
    v_add_f32 v14, v14, v26
    v_add_f32 v15, v15, v27
    v_add_f32 v8, v8, v10
    v_add_f32 v9, v9, v11
    v_add_f32 v12, v12, v14
    v_add_f32 v13, v13, v15
    v_add_f32 v8, v8, v12
    v_add_f32 v9, v9, v13
    v_cvt_pk_bf16_f32 v8, v8, v9
    ds_write_b32 v6, v8 offset:4096
    s_waitcnt lgkmcnt(0)
    ds_read_b128 v[16:19], v7 offset:4096
    v_mov_b32 v8, 0
    v_mov_b32 v9, 0
    v_mov_b32 v10, 0
    v_mov_b32 v11, 0
    v_mov_b32 v12, 0
    v_mov_b32 v13, 0
    v_mov_b32 v14, 0
    v_mov_b32 v15, 0
    s_mov_b32 s88, 0
    s_waitcnt lgkmcnt(0)
    v_mov_b32 v165, 1
    s_mov_b64 exec, 1
    buffer_atomic_add v165, off, s[76:79], s3 sc0
    s_mov_b64 exec, -1
L_var16:
    v_dot2_f32_bf16 v20, v32, v16, 0
    v_dot2_f32_bf16 v20, v33, v17, v20
    v_dot2_f32_bf16 v20, v34, v18, v20
    v_dot2_f32_bf16 v20, v35, v19, v20
    v_dot2_f32_bf16 v21, v36, v16, 0
    v_dot2_f32_bf16 v21, v37, v17, v21
    v_dot2_f32_bf16 v21, v38, v18, v21
    v_dot2_f32_bf16 v21, v39, v19, v21
    v_add_f32_dpp v20, v20, v20 row_mirror row_mask:0xf bank_mask:0x3
    v_dot2_f32_bf16 v22, v40, v16, 0
    v_dot2_f32_bf16 v22, v41, v17, v22
    v_dot2_f32_bf16 v22, v42, v18, v22
    v_dot2_f32_bf16 v22, v43, v19, v22
    v_add_f32_dpp v21, v21, v21 row_mirror row_mask:0xf bank_mask:0x3
    v_dot2_f32_bf16 v23, v44, v16, 0
    v_dot2_f32_bf16 v23, v45, v17, v23
    v_dot2_f32_bf16 v23, v46, v18, v23
    v_dot2_f32_bf16 v23, v47, v19, v23
    v_add_f32_dpp v22, v22, v22 row_mirror row_mask:0xf bank_mask:0x3
    v_dot2_f32_bf16 v24, v48, v16, 0
    v_dot2_f32_bf16 v24, v49, v17, v24
    v_dot2_f32_bf16 v24, v50, v18, v24
    v_dot2_f32_bf16 v24, v51, v19, v24
    buffer_load_dwordx4 v[112:115], v1, s[36:39], s85 offen offset:0 nt
    v_add_f32_dpp v23, v23, v23 row_mirror row_mask:0xf bank_mask:0x3
    v_dot2_f32_bf16 v25, v52, v16, 0
    v_dot2_f32_bf16 v25, v53, v17, v25
    v_dot2_f32_bf16 v25, v54, v18, v25
    v_dot2_f32_bf16 v25, v55, v19, v25
    buffer_load_dwordx4 v[116:119], v1, s[36:39], s85 offen offset:1024 nt
    v_add_f32_dpp v24, v24, v24 row_mirror row_mask:0xf bank_mask:0x3
    v_dot2_f32_bf16 v26, v56, v16, 0
    v_dot2_f32_bf16 v26, v57, v17, v26
    v_dot2_f32_bf16 v26, v58, v18, v26
    v_dot2_f32_bf16 v26, v59, v19, v26
    buffer_load_dwordx4 v[120:123], v1, s[36:39], s85 offen offset:2048 nt
    v_add_f32_dpp v25, v25, v25 row_mirror row_mask:0xf bank_mask:0x3
    v_dot2_f32_bf16 v27, v60, v16, 0
    v_dot2_f32_bf16 v27, v61, v17, v27
    v_dot2_f32_bf16 v27, v62, v18, v27
    v_dot2_f32_bf16 v27, v63, v19, v27
    buffer_load_dwordx4 v[124:127], v1, s[36:39], s85 offen offset:3072 nt
    v_add_f32_dpp v26, v26, v26 row_mirror row_mask:0xf bank_mask:0x3
    v_dot2_f32_bf16 v28, v64, v16, 0
    v_dot2_f32_bf16 v28, v65, v17, v28
    v_dot2_f32_bf16 v28, v66, v18, v28
    v_dot2_f32_bf16 v28, v67, v19, v28
    buffer_load_dwordx4 v[128:131], v1, s[36:39], s86 offen offset:0 nt
    v_add_f32_dpp v27, v27, v27 row_mirror row_mask:0xf bank_mask:0x3
    v_dot2_f32_bf16 v29, v68, v16, 0
    v_dot2_f32_bf16 v29, v69, v17, v29
    v_dot2_f32_bf16 v29, v70, v18, v29
    v_dot2_f32_bf16 v29, v71, v19, v29
    buffer_load_dwordx4 v[132:135], v1, s[36:39], s86 offen offset:1024 nt
    v_add_f32_dpp v20, v28, v28 row_mirror row_mask:0xf bank_mask:0xc
    v_dot2_f32_bf16 v28, v72, v16, 0
    v_dot2_f32_bf16 v28, v73, v17, v28
    v_dot2_f32_bf16 v28, v74, v18, v28
    v_dot2_f32_bf16 v28, v75, v19, v28
    buffer_load_dwordx4 v[136:139], v1, s[36:39], s86 offen offset:2048 nt
    v_add_f32_dpp v21, v29, v29 row_mirror row_mask:0xf bank_mask:0xc
    v_dot2_f32_bf16 v29, v76, v16, 0
    v_dot2_f32_bf16 v29, v77, v17, v29
    v_dot2_f32_bf16 v29, v78, v18, v29
    v_dot2_f32_bf16 v29, v79, v19, v29
    buffer_load_dwordx4 v[140:143], v1, s[36:39], s86 offen offset:3072 nt
    v_add_f32_dpp v22, v28, v28 row_mirror row_mask:0xf bank_mask:0xc
    v_dot2_f32_bf16 v28, v80, v16, 0
    v_dot2_f32_bf16 v28, v81, v17, v28
    v_dot2_f32_bf16 v28, v82, v18, v28
    v_dot2_f32_bf16 v28, v83, v19, v28
    buffer_load_dwordx4 v[144:147], v1, s[36:39], s87 offen offset:0 nt
    v_add_f32_dpp v23, v29, v29 row_mirror row_mask:0xf bank_mask:0xc
    v_dot2_f32_bf16 v29, v84, v16, 0
    v_dot2_f32_bf16 v29, v85, v17, v29
    v_dot2_f32_bf16 v29, v86, v18, v29
    v_dot2_f32_bf16 v29, v87, v19, v29
    buffer_load_dwordx4 v[148:151], v1, s[36:39], s87 offen offset:1024 nt
    v_add_f32_dpp v24, v28, v28 row_mirror row_mask:0xf bank_mask:0xc
    v_dot2_f32_bf16 v28, v88, v16, 0
    v_dot2_f32_bf16 v28, v89, v17, v28
    v_dot2_f32_bf16 v28, v90, v18, v28
    v_dot2_f32_bf16 v28, v91, v19, v28
    buffer_load_dwordx4 v[152:155], v1, s[36:39], s87 offen offset:2048 nt
    v_add_f32_dpp v25, v29, v29 row_mirror row_mask:0xf bank_mask:0xc
    v_dot2_f32_bf16 v29, v92, v16, 0
    v_dot2_f32_bf16 v29, v93, v17, v29
    v_dot2_f32_bf16 v29, v94, v18, v29
    v_dot2_f32_bf16 v29, v95, v19, v29
    buffer_load_dwordx4 v[156:159], v1, s[36:39], s87 offen offset:3072 nt
    v_add_f32_dpp v26, v28, v28 row_mirror row_mask:0xf bank_mask:0xc
    v_add_f32_dpp v20, v20, v20 row_half_mirror row_mask:0xf bank_mask:0x5
    v_add_f32_dpp v21, v21, v21 row_half_mirror row_mask:0xf bank_mask:0x5
    v_add_f32_dpp v22, v22, v22 row_half_mirror row_mask:0xf bank_mask:0x5
    v_add_f32_dpp v27, v29, v29 row_mirror row_mask:0xf bank_mask:0xc
    v_add_f32_dpp v23, v23, v23 row_half_mirror row_mask:0xf bank_mask:0x5
    v_add_f32_dpp v20, v24, v24 row_half_mirror row_mask:0xf bank_mask:0xa
    v_add_f32_dpp v21, v25, v25 row_half_mirror row_mask:0xf bank_mask:0xa
    v_add_f32_dpp v22, v26, v26 row_half_mirror row_mask:0xf bank_mask:0xa
    v_add_f32_dpp v23, v27, v27 row_half_mirror row_mask:0xf bank_mask:0xa
    v_add_f32_dpp v20, v20, v20 quad_perm:[3,2,1,0] row_mask:0xf bank_mask:0xf
    v_add_f32_dpp v21, v21, v21 quad_perm:[3,2,1,0] row_mask:0xf bank_mask:0xf
    v_add_f32_dpp v22, v22, v22 quad_perm:[3,2,1,0] row_mask:0xf bank_mask:0xf
    v_add_f32_dpp v23, v23, v23 quad_perm:[3,2,1,0] row_mask:0xf bank_mask:0xf
    v_cndmask_b32 v20, v20, v22, s[92:93]
    v_cndmask_b32 v21, v21, v23, s[92:93]
    s_nop 0
    v_add_f32_dpp v20, v20, v20 quad_perm:[1,0,3,2] row_mask:0xf bank_mask:0xf
    v_add_f32_dpp v21, v21, v21 quad_perm:[1,0,3,2] row_mask:0xf bank_mask:0xf
    v_cndmask_b32 v20, v20, v21, s[94:95]
    v_mul_f32 v20, s90, v20
    s_nop 1
    v_max_f32_dpp v21, v20, v20 row_mirror row_mask:0xf bank_mask:0xf
    s_nop 1
    v_max_f32_dpp v21, v21, v21 row_half_mirror row_mask:0xf bank_mask:0xf
    s_nop 1
    v_max_f32_dpp v21, v21, v21 quad_perm:[3,2,1,0] row_mask:0xf bank_mask:0xf
    s_nop 1
    v_max_f32_dpp v21, v21, v21 quad_perm:[1,0,3,2] row_mask:0xf bank_mask:0xf
    v_max_f32 v21, v21, v2
    v_sub_f32 v22, v2, v21
    v_sub_f32 v20, v20, v21
    v_exp_f32 v22, v22
    v_exp_f32 v20, v20
    v_mov_b32 v2, v21
    v_cvt_pk_bf16_f32 v4, v20, 0
    v_cvt_pk_bf16_f32 v5, 0, v20
    v_mul_f32 v8, v8, v22
    v_mul_f32 v9, v9, v22
    v_mul_f32 v10, v10, v22
    v_mul_f32 v11, v11, v22
    v_mul_f32 v12, v12, v22
    v_mul_f32 v13, v13, v22
    v_mul_f32 v14, v14, v22
    v_mul_f32 v15, v15, v22
    v_fma_f32 v3, v3, v22, v5
    s_waitcnt vmcnt(12)
    v_readfirstlane_b32 s89, v165
    s_cmp_ge_u32 s89, 128
    s_cbranch_scc1 L_last0_16
    s_lshl_b32 s89, s89, 14
    s_add_u32 s98, s97, s89
    s_add_u32 s99, s98, 4096
    s_add_u32 s100, s98, 8192
    s_add_u32 s101, s98, 12288
    v_dot2c_f32_bf16_dpp v8, v4, v96 row_newbcast:0 row_mask:0xf bank_mask:0xf
    v_dot2c_f32_bf16_dpp v9, v5, v96 row_newbcast:0 row_mask:0xf bank_mask:0xf
    v_dot2c_f32_bf16_dpp v10, v4, v97 row_newbcast:0 row_mask:0xf bank_mask:0xf
    v_dot2c_f32_bf16_dpp v11, v5, v97 row_newbcast:0 row_mask:0xf bank_mask:0xf
    v_dot2c_f32_bf16_dpp v12, v4, v98 row_newbcast:0 row_mask:0xf bank_mask:0xf
    v_dot2c_f32_bf16_dpp v13, v5, v98 row_newbcast:0 row_mask:0xf bank_mask:0xf
    v_dot2c_f32_bf16_dpp v14, v4, v99 row_newbcast:0 row_mask:0xf bank_mask:0xf
    v_dot2c_f32_bf16_dpp v15, v5, v99 row_newbcast:0 row_mask:0xf bank_mask:0xf
    buffer_load_dwordx4 v[32:35], v1, s[32:35], s98 offen offset:0 nt
    v_dot2c_f32_bf16_dpp v8, v4, v100 row_newbcast:1 row_mask:0xf bank_mask:0xf
    v_dot2c_f32_bf16_dpp v9, v5, v100 row_newbcast:1 row_mask:0xf bank_mask:0xf
    v_dot2c_f32_bf16_dpp v10, v4, v101 row_newbcast:1 row_mask:0xf bank_mask:0xf
    v_dot2c_f32_bf16_dpp v11, v5, v101 row_newbcast:1 row_mask:0xf bank_mask:0xf
    v_dot2c_f32_bf16_dpp v12, v4, v102 row_newbcast:1 row_mask:0xf bank_mask:0xf
    v_dot2c_f32_bf16_dpp v13, v5, v102 row_newbcast:1 row_mask:0xf bank_mask:0xf
    v_dot2c_f32_bf16_dpp v14, v4, v103 row_newbcast:1 row_mask:0xf bank_mask:0xf
    v_dot2c_f32_bf16_dpp v15, v5, v103 row_newbcast:1 row_mask:0xf bank_mask:0xf
    buffer_load_dwordx4 v[36:39], v1, s[32:35], s98 offen offset:1024 nt
    v_dot2c_f32_bf16_dpp v8, v4, v104 row_newbcast:2 row_mask:0xf bank_mask:0xf
    v_dot2c_f32_bf16_dpp v9, v5, v104 row_newbcast:2 row_mask:0xf bank_mask:0xf
    v_dot2c_f32_bf16_dpp v10, v4, v105 row_newbcast:2 row_mask:0xf bank_mask:0xf
    v_dot2c_f32_bf16_dpp v11, v5, v105 row_newbcast:2 row_mask:0xf bank_mask:0xf
    v_dot2c_f32_bf16_dpp v12, v4, v106 row_newbcast:2 row_mask:0xf bank_mask:0xf
    v_dot2c_f32_bf16_dpp v13, v5, v106 row_newbcast:2 row_mask:0xf bank_mask:0xf
    v_dot2c_f32_bf16_dpp v14, v4, v107 row_newbcast:2 row_mask:0xf bank_mask:0xf
    v_dot2c_f32_bf16_dpp v15, v5, v107 row_newbcast:2 row_mask:0xf bank_mask:0xf
    buffer_load_dwordx4 v[40:43], v1, s[32:35], s98 offen offset:2048 nt
    v_dot2c_f32_bf16_dpp v8, v4, v108 row_newbcast:3 row_mask:0xf bank_mask:0xf
    v_dot2c_f32_bf16_dpp v9, v5, v108 row_newbcast:3 row_mask:0xf bank_mask:0xf
    v_dot2c_f32_bf16_dpp v10, v4, v109 row_newbcast:3 row_mask:0xf bank_mask:0xf
    v_dot2c_f32_bf16_dpp v11, v5, v109 row_newbcast:3 row_mask:0xf bank_mask:0xf
    v_dot2c_f32_bf16_dpp v12, v4, v110 row_newbcast:3 row_mask:0xf bank_mask:0xf
    v_dot2c_f32_bf16_dpp v13, v5, v110 row_newbcast:3 row_mask:0xf bank_mask:0xf
    v_dot2c_f32_bf16_dpp v14, v4, v111 row_newbcast:3 row_mask:0xf bank_mask:0xf
    v_dot2c_f32_bf16_dpp v15, v5, v111 row_newbcast:3 row_mask:0xf bank_mask:0xf
    buffer_load_dwordx4 v[44:47], v1, s[32:35], s98 offen offset:3072 nt
    s_waitcnt vmcnt(15)
    v_dot2c_f32_bf16_dpp v8, v4, v112 row_newbcast:4 row_mask:0xf bank_mask:0xf
    v_dot2c_f32_bf16_dpp v9, v5, v112 row_newbcast:4 row_mask:0xf bank_mask:0xf
    v_dot2c_f32_bf16_dpp v10, v4, v113 row_newbcast:4 row_mask:0xf bank_mask:0xf
    v_dot2c_f32_bf16_dpp v11, v5, v113 row_newbcast:4 row_mask:0xf bank_mask:0xf
    v_dot2c_f32_bf16_dpp v12, v4, v114 row_newbcast:4 row_mask:0xf bank_mask:0xf
    v_dot2c_f32_bf16_dpp v13, v5, v114 row_newbcast:4 row_mask:0xf bank_mask:0xf
    v_dot2c_f32_bf16_dpp v14, v4, v115 row_newbcast:4 row_mask:0xf bank_mask:0xf
    v_dot2c_f32_bf16_dpp v15, v5, v115 row_newbcast:4 row_mask:0xf bank_mask:0xf
    buffer_load_dwordx4 v[48:51], v1, s[32:35], s99 offen offset:0 nt
    s_waitcnt vmcnt(15)
    v_dot2c_f32_bf16_dpp v8, v4, v116 row_newbcast:5 row_mask:0xf bank_mask:0xf
    v_dot2c_f32_bf16_dpp v9, v5, v116 row_newbcast:5 row_mask:0xf bank_mask:0xf
    v_dot2c_f32_bf16_dpp v10, v4, v117 row_newbcast:5 row_mask:0xf bank_mask:0xf
    v_dot2c_f32_bf16_dpp v11, v5, v117 row_newbcast:5 row_mask:0xf bank_mask:0xf
    v_dot2c_f32_bf16_dpp v12, v4, v118 row_newbcast:5 row_mask:0xf bank_mask:0xf
    v_dot2c_f32_bf16_dpp v13, v5, v118 row_newbcast:5 row_mask:0xf bank_mask:0xf
    v_dot2c_f32_bf16_dpp v14, v4, v119 row_newbcast:5 row_mask:0xf bank_mask:0xf
    v_dot2c_f32_bf16_dpp v15, v5, v119 row_newbcast:5 row_mask:0xf bank_mask:0xf
    buffer_load_dwordx4 v[52:55], v1, s[32:35], s99 offen offset:1024 nt
    s_waitcnt vmcnt(15)
    v_dot2c_f32_bf16_dpp v8, v4, v120 row_newbcast:6 row_mask:0xf bank_mask:0xf
    v_dot2c_f32_bf16_dpp v9, v5, v120 row_newbcast:6 row_mask:0xf bank_mask:0xf
    v_dot2c_f32_bf16_dpp v10, v4, v121 row_newbcast:6 row_mask:0xf bank_mask:0xf
    v_dot2c_f32_bf16_dpp v11, v5, v121 row_newbcast:6 row_mask:0xf bank_mask:0xf
    v_dot2c_f32_bf16_dpp v12, v4, v122 row_newbcast:6 row_mask:0xf bank_mask:0xf
    v_dot2c_f32_bf16_dpp v13, v5, v122 row_newbcast:6 row_mask:0xf bank_mask:0xf
    v_dot2c_f32_bf16_dpp v14, v4, v123 row_newbcast:6 row_mask:0xf bank_mask:0xf
    v_dot2c_f32_bf16_dpp v15, v5, v123 row_newbcast:6 row_mask:0xf bank_mask:0xf
    buffer_load_dwordx4 v[56:59], v1, s[32:35], s99 offen offset:2048 nt
    s_waitcnt vmcnt(15)
    v_dot2c_f32_bf16_dpp v8, v4, v124 row_newbcast:7 row_mask:0xf bank_mask:0xf
    v_dot2c_f32_bf16_dpp v9, v5, v124 row_newbcast:7 row_mask:0xf bank_mask:0xf
    v_dot2c_f32_bf16_dpp v10, v4, v125 row_newbcast:7 row_mask:0xf bank_mask:0xf
    v_dot2c_f32_bf16_dpp v11, v5, v125 row_newbcast:7 row_mask:0xf bank_mask:0xf
    v_dot2c_f32_bf16_dpp v12, v4, v126 row_newbcast:7 row_mask:0xf bank_mask:0xf
    v_dot2c_f32_bf16_dpp v13, v5, v126 row_newbcast:7 row_mask:0xf bank_mask:0xf
    v_dot2c_f32_bf16_dpp v14, v4, v127 row_newbcast:7 row_mask:0xf bank_mask:0xf
    v_dot2c_f32_bf16_dpp v15, v5, v127 row_newbcast:7 row_mask:0xf bank_mask:0xf
    buffer_load_dwordx4 v[60:63], v1, s[32:35], s99 offen offset:3072 nt
    s_waitcnt vmcnt(15)
    v_dot2c_f32_bf16_dpp v8, v4, v128 row_newbcast:8 row_mask:0xf bank_mask:0xf
    v_dot2c_f32_bf16_dpp v9, v5, v128 row_newbcast:8 row_mask:0xf bank_mask:0xf
    v_dot2c_f32_bf16_dpp v10, v4, v129 row_newbcast:8 row_mask:0xf bank_mask:0xf
    v_dot2c_f32_bf16_dpp v11, v5, v129 row_newbcast:8 row_mask:0xf bank_mask:0xf
    v_dot2c_f32_bf16_dpp v12, v4, v130 row_newbcast:8 row_mask:0xf bank_mask:0xf
    v_dot2c_f32_bf16_dpp v13, v5, v130 row_newbcast:8 row_mask:0xf bank_mask:0xf
    v_dot2c_f32_bf16_dpp v14, v4, v131 row_newbcast:8 row_mask:0xf bank_mask:0xf
    v_dot2c_f32_bf16_dpp v15, v5, v131 row_newbcast:8 row_mask:0xf bank_mask:0xf
    buffer_load_dwordx4 v[64:67], v1, s[32:35], s100 offen offset:0 nt
    s_waitcnt vmcnt(15)
    v_dot2c_f32_bf16_dpp v8, v4, v132 row_newbcast:9 row_mask:0xf bank_mask:0xf
    v_dot2c_f32_bf16_dpp v9, v5, v132 row_newbcast:9 row_mask:0xf bank_mask:0xf
    v_dot2c_f32_bf16_dpp v10, v4, v133 row_newbcast:9 row_mask:0xf bank_mask:0xf
    v_dot2c_f32_bf16_dpp v11, v5, v133 row_newbcast:9 row_mask:0xf bank_mask:0xf
    v_dot2c_f32_bf16_dpp v12, v4, v134 row_newbcast:9 row_mask:0xf bank_mask:0xf
    v_dot2c_f32_bf16_dpp v13, v5, v134 row_newbcast:9 row_mask:0xf bank_mask:0xf
    v_dot2c_f32_bf16_dpp v14, v4, v135 row_newbcast:9 row_mask:0xf bank_mask:0xf
    v_dot2c_f32_bf16_dpp v15, v5, v135 row_newbcast:9 row_mask:0xf bank_mask:0xf
    buffer_load_dwordx4 v[68:71], v1, s[32:35], s100 offen offset:1024 nt
    s_waitcnt vmcnt(15)
    v_dot2c_f32_bf16_dpp v8, v4, v136 row_newbcast:10 row_mask:0xf bank_mask:0xf
    v_dot2c_f32_bf16_dpp v9, v5, v136 row_newbcast:10 row_mask:0xf bank_mask:0xf
    v_dot2c_f32_bf16_dpp v10, v4, v137 row_newbcast:10 row_mask:0xf bank_mask:0xf
    v_dot2c_f32_bf16_dpp v11, v5, v137 row_newbcast:10 row_mask:0xf bank_mask:0xf
    v_dot2c_f32_bf16_dpp v12, v4, v138 row_newbcast:10 row_mask:0xf bank_mask:0xf
    v_dot2c_f32_bf16_dpp v13, v5, v138 row_newbcast:10 row_mask:0xf bank_mask:0xf
    v_dot2c_f32_bf16_dpp v14, v4, v139 row_newbcast:10 row_mask:0xf bank_mask:0xf
    v_dot2c_f32_bf16_dpp v15, v5, v139 row_newbcast:10 row_mask:0xf bank_mask:0xf
    buffer_load_dwordx4 v[72:75], v1, s[32:35], s100 offen offset:2048 nt
    s_waitcnt vmcnt(15)
    v_dot2c_f32_bf16_dpp v8, v4, v140 row_newbcast:11 row_mask:0xf bank_mask:0xf
    v_dot2c_f32_bf16_dpp v9, v5, v140 row_newbcast:11 row_mask:0xf bank_mask:0xf
    v_dot2c_f32_bf16_dpp v10, v4, v141 row_newbcast:11 row_mask:0xf bank_mask:0xf
    v_dot2c_f32_bf16_dpp v11, v5, v141 row_newbcast:11 row_mask:0xf bank_mask:0xf
    v_dot2c_f32_bf16_dpp v12, v4, v142 row_newbcast:11 row_mask:0xf bank_mask:0xf
    v_dot2c_f32_bf16_dpp v13, v5, v142 row_newbcast:11 row_mask:0xf bank_mask:0xf
    v_dot2c_f32_bf16_dpp v14, v4, v143 row_newbcast:11 row_mask:0xf bank_mask:0xf
    v_dot2c_f32_bf16_dpp v15, v5, v143 row_newbcast:11 row_mask:0xf bank_mask:0xf
    buffer_load_dwordx4 v[76:79], v1, s[32:35], s100 offen offset:3072 nt
    s_waitcnt vmcnt(15)
    v_dot2c_f32_bf16_dpp v8, v4, v144 row_newbcast:12 row_mask:0xf bank_mask:0xf
    v_dot2c_f32_bf16_dpp v9, v5, v144 row_newbcast:12 row_mask:0xf bank_mask:0xf
    v_dot2c_f32_bf16_dpp v10, v4, v145 row_newbcast:12 row_mask:0xf bank_mask:0xf
    v_dot2c_f32_bf16_dpp v11, v5, v145 row_newbcast:12 row_mask:0xf bank_mask:0xf
    v_dot2c_f32_bf16_dpp v12, v4, v146 row_newbcast:12 row_mask:0xf bank_mask:0xf
    v_dot2c_f32_bf16_dpp v13, v5, v146 row_newbcast:12 row_mask:0xf bank_mask:0xf
    v_dot2c_f32_bf16_dpp v14, v4, v147 row_newbcast:12 row_mask:0xf bank_mask:0xf
    v_dot2c_f32_bf16_dpp v15, v5, v147 row_newbcast:12 row_mask:0xf bank_mask:0xf
    buffer_load_dwordx4 v[80:83], v1, s[32:35], s101 offen offset:0 nt
    s_waitcnt vmcnt(15)
    v_dot2c_f32_bf16_dpp v8, v4, v148 row_newbcast:13 row_mask:0xf bank_mask:0xf
    v_dot2c_f32_bf16_dpp v9, v5, v148 row_newbcast:13 row_mask:0xf bank_mask:0xf
    v_dot2c_f32_bf16_dpp v10, v4, v149 row_newbcast:13 row_mask:0xf bank_mask:0xf
    v_dot2c_f32_bf16_dpp v11, v5, v149 row_newbcast:13 row_mask:0xf bank_mask:0xf
    v_dot2c_f32_bf16_dpp v12, v4, v150 row_newbcast:13 row_mask:0xf bank_mask:0xf
    v_dot2c_f32_bf16_dpp v13, v5, v150 row_newbcast:13 row_mask:0xf bank_mask:0xf
    v_dot2c_f32_bf16_dpp v14, v4, v151 row_newbcast:13 row_mask:0xf bank_mask:0xf
    v_dot2c_f32_bf16_dpp v15, v5, v151 row_newbcast:13 row_mask:0xf bank_mask:0xf
    buffer_load_dwordx4 v[84:87], v1, s[32:35], s101 offen offset:1024 nt
    s_waitcnt vmcnt(15)
    v_dot2c_f32_bf16_dpp v8, v4, v152 row_newbcast:14 row_mask:0xf bank_mask:0xf
    v_dot2c_f32_bf16_dpp v9, v5, v152 row_newbcast:14 row_mask:0xf bank_mask:0xf
    v_dot2c_f32_bf16_dpp v10, v4, v153 row_newbcast:14 row_mask:0xf bank_mask:0xf
    v_dot2c_f32_bf16_dpp v11, v5, v153 row_newbcast:14 row_mask:0xf bank_mask:0xf
    v_dot2c_f32_bf16_dpp v12, v4, v154 row_newbcast:14 row_mask:0xf bank_mask:0xf
    v_dot2c_f32_bf16_dpp v13, v5, v154 row_newbcast:14 row_mask:0xf bank_mask:0xf
    v_dot2c_f32_bf16_dpp v14, v4, v155 row_newbcast:14 row_mask:0xf bank_mask:0xf
    v_dot2c_f32_bf16_dpp v15, v5, v155 row_newbcast:14 row_mask:0xf bank_mask:0xf
    buffer_load_dwordx4 v[88:91], v1, s[32:35], s101 offen offset:2048 nt
    s_waitcnt vmcnt(15)
    v_dot2c_f32_bf16_dpp v8, v4, v156 row_newbcast:15 row_mask:0xf bank_mask:0xf
    v_dot2c_f32_bf16_dpp v9, v5, v156 row_newbcast:15 row_mask:0xf bank_mask:0xf
    v_dot2c_f32_bf16_dpp v10, v4, v157 row_newbcast:15 row_mask:0xf bank_mask:0xf
    v_dot2c_f32_bf16_dpp v11, v5, v157 row_newbcast:15 row_mask:0xf bank_mask:0xf
    v_dot2c_f32_bf16_dpp v12, v4, v158 row_newbcast:15 row_mask:0xf bank_mask:0xf
    v_dot2c_f32_bf16_dpp v13, v5, v158 row_newbcast:15 row_mask:0xf bank_mask:0xf
    v_dot2c_f32_bf16_dpp v14, v4, v159 row_newbcast:15 row_mask:0xf bank_mask:0xf
    v_dot2c_f32_bf16_dpp v15, v5, v159 row_newbcast:15 row_mask:0xf bank_mask:0xf
    buffer_load_dwordx4 v[92:95], v1, s[32:35], s101 offen offset:3072 nt
L_loop16:
    s_mov_b32 s84, s98
    s_mov_b32 s85, s99
    s_mov_b32 s86, s100
    s_mov_b32 s87, s101
    v_mov_b32 v165, 1
    s_mov_b64 exec, 1
    buffer_atomic_add v165, off, s[76:79], s3 sc0
    s_mov_b64 exec, -1
    s_waitcnt vmcnt(16)
    v_dot2_f32_bf16 v20, v32, v16, 0
    v_dot2_f32_bf16 v20, v33, v17, v20
    v_dot2_f32_bf16 v20, v34, v18, v20
    v_dot2_f32_bf16 v20, v35, v19, v20
    buffer_load_dwordx4 v[96:99], v1, s[36:39], s84 offen offset:0 nt
    s_waitcnt vmcnt(16)
    v_dot2_f32_bf16 v21, v36, v16, 0
    v_dot2_f32_bf16 v21, v37, v17, v21
    v_dot2_f32_bf16 v21, v38, v18, v21
    v_dot2_f32_bf16 v21, v39, v19, v21
    buffer_load_dwordx4 v[100:103], v1, s[36:39], s84 offen offset:1024 nt
    v_add_f32_dpp v20, v20, v20 row_mirror row_mask:0xf bank_mask:0x3
    s_waitcnt vmcnt(16)
    v_dot2_f32_bf16 v22, v40, v16, 0
    v_dot2_f32_bf16 v22, v41, v17, v22
    v_dot2_f32_bf16 v22, v42, v18, v22
    v_dot2_f32_bf16 v22, v43, v19, v22
    buffer_load_dwordx4 v[104:107], v1, s[36:39], s84 offen offset:2048 nt
    v_add_f32_dpp v21, v21, v21 row_mirror row_mask:0xf bank_mask:0x3
    s_waitcnt vmcnt(16)
    v_dot2_f32_bf16 v23, v44, v16, 0
    v_dot2_f32_bf16 v23, v45, v17, v23
    v_dot2_f32_bf16 v23, v46, v18, v23
    v_dot2_f32_bf16 v23, v47, v19, v23
    buffer_load_dwordx4 v[108:111], v1, s[36:39], s84 offen offset:3072 nt
    v_add_f32_dpp v22, v22, v22 row_mirror row_mask:0xf bank_mask:0x3
    s_waitcnt vmcnt(16)
    v_dot2_f32_bf16 v24, v48, v16, 0
    v_dot2_f32_bf16 v24, v49, v17, v24
    v_dot2_f32_bf16 v24, v50, v18, v24
    v_dot2_f32_bf16 v24, v51, v19, v24
    buffer_load_dwordx4 v[112:115], v1, s[36:39], s85 offen offset:0 nt
    v_add_f32_dpp v23, v23, v23 row_mirror row_mask:0xf bank_mask:0x3
    s_waitcnt vmcnt(16)
    v_dot2_f32_bf16 v25, v52, v16, 0
    v_dot2_f32_bf16 v25, v53, v17, v25
    v_dot2_f32_bf16 v25, v54, v18, v25
    v_dot2_f32_bf16 v25, v55, v19, v25
    buffer_load_dwordx4 v[116:119], v1, s[36:39], s85 offen offset:1024 nt
    v_add_f32_dpp v24, v24, v24 row_mirror row_mask:0xf bank_mask:0x3
    s_waitcnt vmcnt(16)
    v_dot2_f32_bf16 v26, v56, v16, 0
    v_dot2_f32_bf16 v26, v57, v17, v26
    v_dot2_f32_bf16 v26, v58, v18, v26
    v_dot2_f32_bf16 v26, v59, v19, v26
    buffer_load_dwordx4 v[120:123], v1, s[36:39], s85 offen offset:2048 nt
    v_add_f32_dpp v25, v25, v25 row_mirror row_mask:0xf bank_mask:0x3
    s_waitcnt vmcnt(16)
    v_dot2_f32_bf16 v27, v60, v16, 0
    v_dot2_f32_bf16 v27, v61, v17, v27
    v_dot2_f32_bf16 v27, v62, v18, v27
    v_dot2_f32_bf16 v27, v63, v19, v27
    buffer_load_dwordx4 v[124:127], v1, s[36:39], s85 offen offset:3072 nt
    v_add_f32_dpp v26, v26, v26 row_mirror row_mask:0xf bank_mask:0x3
    s_waitcnt vmcnt(16)
    v_dot2_f32_bf16 v28, v64, v16, 0
    v_dot2_f32_bf16 v28, v65, v17, v28
    v_dot2_f32_bf16 v28, v66, v18, v28
    v_dot2_f32_bf16 v28, v67, v19, v28
    buffer_load_dwordx4 v[128:131], v1, s[36:39], s86 offen offset:0 nt
    v_add_f32_dpp v27, v27, v27 row_mirror row_mask:0xf bank_mask:0x3
    s_waitcnt vmcnt(16)
    v_dot2_f32_bf16 v29, v68, v16, 0
    v_dot2_f32_bf16 v29, v69, v17, v29
    v_dot2_f32_bf16 v29, v70, v18, v29
    v_dot2_f32_bf16 v29, v71, v19, v29
    buffer_load_dwordx4 v[132:135], v1, s[36:39], s86 offen offset:1024 nt
    v_add_f32_dpp v20, v28, v28 row_mirror row_mask:0xf bank_mask:0xc
    s_waitcnt vmcnt(16)
    v_dot2_f32_bf16 v28, v72, v16, 0
    v_dot2_f32_bf16 v28, v73, v17, v28
    v_dot2_f32_bf16 v28, v74, v18, v28
    v_dot2_f32_bf16 v28, v75, v19, v28
    buffer_load_dwordx4 v[136:139], v1, s[36:39], s86 offen offset:2048 nt
    v_add_f32_dpp v21, v29, v29 row_mirror row_mask:0xf bank_mask:0xc
    s_waitcnt vmcnt(16)
    v_dot2_f32_bf16 v29, v76, v16, 0
    v_dot2_f32_bf16 v29, v77, v17, v29
    v_dot2_f32_bf16 v29, v78, v18, v29
    v_dot2_f32_bf16 v29, v79, v19, v29
    buffer_load_dwordx4 v[140:143], v1, s[36:39], s86 offen offset:3072 nt
    v_add_f32_dpp v22, v28, v28 row_mirror row_mask:0xf bank_mask:0xc
    s_waitcnt vmcnt(16)
    v_dot2_f32_bf16 v28, v80, v16, 0
    v_dot2_f32_bf16 v28, v81, v17, v28
    v_dot2_f32_bf16 v28, v82, v18, v28
    v_dot2_f32_bf16 v28, v83, v19, v28
    buffer_load_dwordx4 v[144:147], v1, s[36:39], s87 offen offset:0 nt
    v_add_f32_dpp v23, v29, v29 row_mirror row_mask:0xf bank_mask:0xc
    s_waitcnt vmcnt(16)
    v_dot2_f32_bf16 v29, v84, v16, 0
    v_dot2_f32_bf16 v29, v85, v17, v29
    v_dot2_f32_bf16 v29, v86, v18, v29
    v_dot2_f32_bf16 v29, v87, v19, v29
    buffer_load_dwordx4 v[148:151], v1, s[36:39], s87 offen offset:1024 nt
    v_add_f32_dpp v24, v28, v28 row_mirror row_mask:0xf bank_mask:0xc
    s_waitcnt vmcnt(16)
    v_dot2_f32_bf16 v28, v88, v16, 0
    v_dot2_f32_bf16 v28, v89, v17, v28
    v_dot2_f32_bf16 v28, v90, v18, v28
    v_dot2_f32_bf16 v28, v91, v19, v28
    buffer_load_dwordx4 v[152:155], v1, s[36:39], s87 offen offset:2048 nt
    v_add_f32_dpp v25, v29, v29 row_mirror row_mask:0xf bank_mask:0xc
    s_waitcnt vmcnt(16)
    v_dot2_f32_bf16 v29, v92, v16, 0
    v_dot2_f32_bf16 v29, v93, v17, v29
    v_dot2_f32_bf16 v29, v94, v18, v29
    v_dot2_f32_bf16 v29, v95, v19, v29
    buffer_load_dwordx4 v[156:159], v1, s[36:39], s87 offen offset:3072 nt
    v_add_f32_dpp v26, v28, v28 row_mirror row_mask:0xf bank_mask:0xc
    v_add_f32_dpp v20, v20, v20 row_half_mirror row_mask:0xf bank_mask:0x5
    v_add_f32_dpp v21, v21, v21 row_half_mirror row_mask:0xf bank_mask:0x5
    v_add_f32_dpp v22, v22, v22 row_half_mirror row_mask:0xf bank_mask:0x5
    v_add_f32_dpp v27, v29, v29 row_mirror row_mask:0xf bank_mask:0xc
    v_add_f32_dpp v23, v23, v23 row_half_mirror row_mask:0xf bank_mask:0x5
    v_add_f32_dpp v20, v24, v24 row_half_mirror row_mask:0xf bank_mask:0xa
    v_add_f32_dpp v21, v25, v25 row_half_mirror row_mask:0xf bank_mask:0xa
    v_add_f32_dpp v22, v26, v26 row_half_mirror row_mask:0xf bank_mask:0xa
    v_add_f32_dpp v23, v27, v27 row_half_mirror row_mask:0xf bank_mask:0xa
    v_add_f32_dpp v20, v20, v20 quad_perm:[3,2,1,0] row_mask:0xf bank_mask:0xf
    v_add_f32_dpp v21, v21, v21 quad_perm:[3,2,1,0] row_mask:0xf bank_mask:0xf
    v_add_f32_dpp v22, v22, v22 quad_perm:[3,2,1,0] row_mask:0xf bank_mask:0xf
    v_add_f32_dpp v23, v23, v23 quad_perm:[3,2,1,0] row_mask:0xf bank_mask:0xf
    v_cndmask_b32 v20, v20, v22, s[92:93]
    v_cndmask_b32 v21, v21, v23, s[92:93]
    s_nop 0
    v_add_f32_dpp v20, v20, v20 quad_perm:[1,0,3,2] row_mask:0xf bank_mask:0xf
    v_add_f32_dpp v21, v21, v21 quad_perm:[1,0,3,2] row_mask:0xf bank_mask:0xf
    v_cndmask_b32 v20, v20, v21, s[94:95]
    v_mul_f32 v20, s90, v20
    s_nop 1
    v_max_f32_dpp v21, v20, v20 row_mirror row_mask:0xf bank_mask:0xf
    s_nop 1
    v_max_f32_dpp v21, v21, v21 row_half_mirror row_mask:0xf bank_mask:0xf
    s_nop 1
    v_max_f32_dpp v21, v21, v21 quad_perm:[3,2,1,0] row_mask:0xf bank_mask:0xf
    s_nop 1
    v_max_f32_dpp v21, v21, v21 quad_perm:[1,0,3,2] row_mask:0xf bank_mask:0xf
    v_max_f32 v21, v21, v2
    v_sub_f32 v22, v2, v21
    v_sub_f32 v20, v20, v21
    v_exp_f32 v22, v22
    v_exp_f32 v20, v20
    v_mov_b32 v2, v21
    v_cvt_pk_bf16_f32 v4, v20, 0
    v_cvt_pk_bf16_f32 v5, 0, v20
    v_mul_f32 v8, v8, v22
    v_mul_f32 v9, v9, v22
    v_mul_f32 v10, v10, v22
    v_mul_f32 v11, v11, v22
    v_mul_f32 v12, v12, v22
    v_mul_f32 v13, v13, v22
    v_mul_f32 v14, v14, v22
    v_mul_f32 v15, v15, v22
    v_fma_f32 v3, v3, v22, v5
    s_waitcnt vmcnt(16)
    v_readfirstlane_b32 s89, v165
    s_cmp_ge_u32 s89, 128
    s_cbranch_scc1 L_last1_16
    s_lshl_b32 s89, s89, 14
    s_add_u32 s98, s97, s89
    s_add_u32 s99, s98, 4096
    s_add_u32 s100, s98, 8192
    s_add_u32 s101, s98, 12288
    s_waitcnt vmcnt(15)
    v_dot2c_f32_bf16_dpp v8, v4, v96 row_newbcast:0 row_mask:0xf bank_mask:0xf
    v_dot2c_f32_bf16_dpp v9, v5, v96 row_newbcast:0 row_mask:0xf bank_mask:0xf
    v_dot2c_f32_bf16_dpp v10, v4, v97 row_newbcast:0 row_mask:0xf bank_mask:0xf
    v_dot2c_f32_bf16_dpp v11, v5, v97 row_newbcast:0 row_mask:0xf bank_mask:0xf
    v_dot2c_f32_bf16_dpp v12, v4, v98 row_newbcast:0 row_mask:0xf bank_mask:0xf
    v_dot2c_f32_bf16_dpp v13, v5, v98 row_newbcast:0 row_mask:0xf bank_mask:0xf
    v_dot2c_f32_bf16_dpp v14, v4, v99 row_newbcast:0 row_mask:0xf bank_mask:0xf
    v_dot2c_f32_bf16_dpp v15, v5, v99 row_newbcast:0 row_mask:0xf bank_mask:0xf
    buffer_load_dwordx4 v[32:35], v1, s[32:35], s98 offen offset:0 nt
    s_waitcnt vmcnt(15)
    v_dot2c_f32_bf16_dpp v8, v4, v100 row_newbcast:1 row_mask:0xf bank_mask:0xf
    v_dot2c_f32_bf16_dpp v9, v5, v100 row_newbcast:1 row_mask:0xf bank_mask:0xf
    v_dot2c_f32_bf16_dpp v10, v4, v101 row_newbcast:1 row_mask:0xf bank_mask:0xf
    v_dot2c_f32_bf16_dpp v11, v5, v101 row_newbcast:1 row_mask:0xf bank_mask:0xf
    v_dot2c_f32_bf16_dpp v12, v4, v102 row_newbcast:1 row_mask:0xf bank_mask:0xf
    v_dot2c_f32_bf16_dpp v13, v5, v102 row_newbcast:1 row_mask:0xf bank_mask:0xf
    v_dot2c_f32_bf16_dpp v14, v4, v103 row_newbcast:1 row_mask:0xf bank_mask:0xf
    v_dot2c_f32_bf16_dpp v15, v5, v103 row_newbcast:1 row_mask:0xf bank_mask:0xf
    buffer_load_dwordx4 v[36:39], v1, s[32:35], s98 offen offset:1024 nt
    s_waitcnt vmcnt(15)
    v_dot2c_f32_bf16_dpp v8, v4, v104 row_newbcast:2 row_mask:0xf bank_mask:0xf
    v_dot2c_f32_bf16_dpp v9, v5, v104 row_newbcast:2 row_mask:0xf bank_mask:0xf
    v_dot2c_f32_bf16_dpp v10, v4, v105 row_newbcast:2 row_mask:0xf bank_mask:0xf
    v_dot2c_f32_bf16_dpp v11, v5, v105 row_newbcast:2 row_mask:0xf bank_mask:0xf
    v_dot2c_f32_bf16_dpp v12, v4, v106 row_newbcast:2 row_mask:0xf bank_mask:0xf
    v_dot2c_f32_bf16_dpp v13, v5, v106 row_newbcast:2 row_mask:0xf bank_mask:0xf
    v_dot2c_f32_bf16_dpp v14, v4, v107 row_newbcast:2 row_mask:0xf bank_mask:0xf
    v_dot2c_f32_bf16_dpp v15, v5, v107 row_newbcast:2 row_mask:0xf bank_mask:0xf
    buffer_load_dwordx4 v[40:43], v1, s[32:35], s98 offen offset:2048 nt
    s_waitcnt vmcnt(15)
    v_dot2c_f32_bf16_dpp v8, v4, v108 row_newbcast:3 row_mask:0xf bank_mask:0xf
    v_dot2c_f32_bf16_dpp v9, v5, v108 row_newbcast:3 row_mask:0xf bank_mask:0xf
    v_dot2c_f32_bf16_dpp v10, v4, v109 row_newbcast:3 row_mask:0xf bank_mask:0xf
    v_dot2c_f32_bf16_dpp v11, v5, v109 row_newbcast:3 row_mask:0xf bank_mask:0xf
    v_dot2c_f32_bf16_dpp v12, v4, v110 row_newbcast:3 row_mask:0xf bank_mask:0xf
    v_dot2c_f32_bf16_dpp v13, v5, v110 row_newbcast:3 row_mask:0xf bank_mask:0xf
    v_dot2c_f32_bf16_dpp v14, v4, v111 row_newbcast:3 row_mask:0xf bank_mask:0xf
    v_dot2c_f32_bf16_dpp v15, v5, v111 row_newbcast:3 row_mask:0xf bank_mask:0xf
    buffer_load_dwordx4 v[44:47], v1, s[32:35], s98 offen offset:3072 nt
    s_waitcnt vmcnt(15)
    v_dot2c_f32_bf16_dpp v8, v4, v112 row_newbcast:4 row_mask:0xf bank_mask:0xf
    v_dot2c_f32_bf16_dpp v9, v5, v112 row_newbcast:4 row_mask:0xf bank_mask:0xf
    v_dot2c_f32_bf16_dpp v10, v4, v113 row_newbcast:4 row_mask:0xf bank_mask:0xf
    v_dot2c_f32_bf16_dpp v11, v5, v113 row_newbcast:4 row_mask:0xf bank_mask:0xf
    v_dot2c_f32_bf16_dpp v12, v4, v114 row_newbcast:4 row_mask:0xf bank_mask:0xf
    v_dot2c_f32_bf16_dpp v13, v5, v114 row_newbcast:4 row_mask:0xf bank_mask:0xf
    v_dot2c_f32_bf16_dpp v14, v4, v115 row_newbcast:4 row_mask:0xf bank_mask:0xf
    v_dot2c_f32_bf16_dpp v15, v5, v115 row_newbcast:4 row_mask:0xf bank_mask:0xf
    buffer_load_dwordx4 v[48:51], v1, s[32:35], s99 offen offset:0 nt
    s_waitcnt vmcnt(15)
    v_dot2c_f32_bf16_dpp v8, v4, v116 row_newbcast:5 row_mask:0xf bank_mask:0xf
    v_dot2c_f32_bf16_dpp v9, v5, v116 row_newbcast:5 row_mask:0xf bank_mask:0xf
    v_dot2c_f32_bf16_dpp v10, v4, v117 row_newbcast:5 row_mask:0xf bank_mask:0xf
    v_dot2c_f32_bf16_dpp v11, v5, v117 row_newbcast:5 row_mask:0xf bank_mask:0xf
    v_dot2c_f32_bf16_dpp v12, v4, v118 row_newbcast:5 row_mask:0xf bank_mask:0xf
    v_dot2c_f32_bf16_dpp v13, v5, v118 row_newbcast:5 row_mask:0xf bank_mask:0xf
    v_dot2c_f32_bf16_dpp v14, v4, v119 row_newbcast:5 row_mask:0xf bank_mask:0xf
    v_dot2c_f32_bf16_dpp v15, v5, v119 row_newbcast:5 row_mask:0xf bank_mask:0xf
    buffer_load_dwordx4 v[52:55], v1, s[32:35], s99 offen offset:1024 nt
    s_waitcnt vmcnt(15)
    v_dot2c_f32_bf16_dpp v8, v4, v120 row_newbcast:6 row_mask:0xf bank_mask:0xf
    v_dot2c_f32_bf16_dpp v9, v5, v120 row_newbcast:6 row_mask:0xf bank_mask:0xf
    v_dot2c_f32_bf16_dpp v10, v4, v121 row_newbcast:6 row_mask:0xf bank_mask:0xf
    v_dot2c_f32_bf16_dpp v11, v5, v121 row_newbcast:6 row_mask:0xf bank_mask:0xf
    v_dot2c_f32_bf16_dpp v12, v4, v122 row_newbcast:6 row_mask:0xf bank_mask:0xf
    v_dot2c_f32_bf16_dpp v13, v5, v122 row_newbcast:6 row_mask:0xf bank_mask:0xf
    v_dot2c_f32_bf16_dpp v14, v4, v123 row_newbcast:6 row_mask:0xf bank_mask:0xf
    v_dot2c_f32_bf16_dpp v15, v5, v123 row_newbcast:6 row_mask:0xf bank_mask:0xf
    buffer_load_dwordx4 v[56:59], v1, s[32:35], s99 offen offset:2048 nt
    s_waitcnt vmcnt(15)
    v_dot2c_f32_bf16_dpp v8, v4, v124 row_newbcast:7 row_mask:0xf bank_mask:0xf
    v_dot2c_f32_bf16_dpp v9, v5, v124 row_newbcast:7 row_mask:0xf bank_mask:0xf
    v_dot2c_f32_bf16_dpp v10, v4, v125 row_newbcast:7 row_mask:0xf bank_mask:0xf
    v_dot2c_f32_bf16_dpp v11, v5, v125 row_newbcast:7 row_mask:0xf bank_mask:0xf
    v_dot2c_f32_bf16_dpp v12, v4, v126 row_newbcast:7 row_mask:0xf bank_mask:0xf
    v_dot2c_f32_bf16_dpp v13, v5, v126 row_newbcast:7 row_mask:0xf bank_mask:0xf
    v_dot2c_f32_bf16_dpp v14, v4, v127 row_newbcast:7 row_mask:0xf bank_mask:0xf
    v_dot2c_f32_bf16_dpp v15, v5, v127 row_newbcast:7 row_mask:0xf bank_mask:0xf
    buffer_load_dwordx4 v[60:63], v1, s[32:35], s99 offen offset:3072 nt
    s_waitcnt vmcnt(15)
    v_dot2c_f32_bf16_dpp v8, v4, v128 row_newbcast:8 row_mask:0xf bank_mask:0xf
    v_dot2c_f32_bf16_dpp v9, v5, v128 row_newbcast:8 row_mask:0xf bank_mask:0xf
    v_dot2c_f32_bf16_dpp v10, v4, v129 row_newbcast:8 row_mask:0xf bank_mask:0xf
    v_dot2c_f32_bf16_dpp v11, v5, v129 row_newbcast:8 row_mask:0xf bank_mask:0xf
    v_dot2c_f32_bf16_dpp v12, v4, v130 row_newbcast:8 row_mask:0xf bank_mask:0xf
    v_dot2c_f32_bf16_dpp v13, v5, v130 row_newbcast:8 row_mask:0xf bank_mask:0xf
    v_dot2c_f32_bf16_dpp v14, v4, v131 row_newbcast:8 row_mask:0xf bank_mask:0xf
    v_dot2c_f32_bf16_dpp v15, v5, v131 row_newbcast:8 row_mask:0xf bank_mask:0xf
    buffer_load_dwordx4 v[64:67], v1, s[32:35], s100 offen offset:0 nt
    s_waitcnt vmcnt(15)
    v_dot2c_f32_bf16_dpp v8, v4, v132 row_newbcast:9 row_mask:0xf bank_mask:0xf
    v_dot2c_f32_bf16_dpp v9, v5, v132 row_newbcast:9 row_mask:0xf bank_mask:0xf
    v_dot2c_f32_bf16_dpp v10, v4, v133 row_newbcast:9 row_mask:0xf bank_mask:0xf
    v_dot2c_f32_bf16_dpp v11, v5, v133 row_newbcast:9 row_mask:0xf bank_mask:0xf
    v_dot2c_f32_bf16_dpp v12, v4, v134 row_newbcast:9 row_mask:0xf bank_mask:0xf
    v_dot2c_f32_bf16_dpp v13, v5, v134 row_newbcast:9 row_mask:0xf bank_mask:0xf
    v_dot2c_f32_bf16_dpp v14, v4, v135 row_newbcast:9 row_mask:0xf bank_mask:0xf
    v_dot2c_f32_bf16_dpp v15, v5, v135 row_newbcast:9 row_mask:0xf bank_mask:0xf
    buffer_load_dwordx4 v[68:71], v1, s[32:35], s100 offen offset:1024 nt
    s_waitcnt vmcnt(15)
    v_dot2c_f32_bf16_dpp v8, v4, v136 row_newbcast:10 row_mask:0xf bank_mask:0xf
    v_dot2c_f32_bf16_dpp v9, v5, v136 row_newbcast:10 row_mask:0xf bank_mask:0xf
    v_dot2c_f32_bf16_dpp v10, v4, v137 row_newbcast:10 row_mask:0xf bank_mask:0xf
    v_dot2c_f32_bf16_dpp v11, v5, v137 row_newbcast:10 row_mask:0xf bank_mask:0xf
    v_dot2c_f32_bf16_dpp v12, v4, v138 row_newbcast:10 row_mask:0xf bank_mask:0xf
    v_dot2c_f32_bf16_dpp v13, v5, v138 row_newbcast:10 row_mask:0xf bank_mask:0xf
    v_dot2c_f32_bf16_dpp v14, v4, v139 row_newbcast:10 row_mask:0xf bank_mask:0xf
    v_dot2c_f32_bf16_dpp v15, v5, v139 row_newbcast:10 row_mask:0xf bank_mask:0xf
    buffer_load_dwordx4 v[72:75], v1, s[32:35], s100 offen offset:2048 nt
    s_waitcnt vmcnt(15)
    v_dot2c_f32_bf16_dpp v8, v4, v140 row_newbcast:11 row_mask:0xf bank_mask:0xf
    v_dot2c_f32_bf16_dpp v9, v5, v140 row_newbcast:11 row_mask:0xf bank_mask:0xf
    v_dot2c_f32_bf16_dpp v10, v4, v141 row_newbcast:11 row_mask:0xf bank_mask:0xf
    v_dot2c_f32_bf16_dpp v11, v5, v141 row_newbcast:11 row_mask:0xf bank_mask:0xf
    v_dot2c_f32_bf16_dpp v12, v4, v142 row_newbcast:11 row_mask:0xf bank_mask:0xf
    v_dot2c_f32_bf16_dpp v13, v5, v142 row_newbcast:11 row_mask:0xf bank_mask:0xf
    v_dot2c_f32_bf16_dpp v14, v4, v143 row_newbcast:11 row_mask:0xf bank_mask:0xf
    v_dot2c_f32_bf16_dpp v15, v5, v143 row_newbcast:11 row_mask:0xf bank_mask:0xf
    buffer_load_dwordx4 v[76:79], v1, s[32:35], s100 offen offset:3072 nt
    s_waitcnt vmcnt(15)
    v_dot2c_f32_bf16_dpp v8, v4, v144 row_newbcast:12 row_mask:0xf bank_mask:0xf
    v_dot2c_f32_bf16_dpp v9, v5, v144 row_newbcast:12 row_mask:0xf bank_mask:0xf
    v_dot2c_f32_bf16_dpp v10, v4, v145 row_newbcast:12 row_mask:0xf bank_mask:0xf
    v_dot2c_f32_bf16_dpp v11, v5, v145 row_newbcast:12 row_mask:0xf bank_mask:0xf
    v_dot2c_f32_bf16_dpp v12, v4, v146 row_newbcast:12 row_mask:0xf bank_mask:0xf
    v_dot2c_f32_bf16_dpp v13, v5, v146 row_newbcast:12 row_mask:0xf bank_mask:0xf
    v_dot2c_f32_bf16_dpp v14, v4, v147 row_newbcast:12 row_mask:0xf bank_mask:0xf
    v_dot2c_f32_bf16_dpp v15, v5, v147 row_newbcast:12 row_mask:0xf bank_mask:0xf
    buffer_load_dwordx4 v[80:83], v1, s[32:35], s101 offen offset:0 nt
    s_waitcnt vmcnt(15)
    v_dot2c_f32_bf16_dpp v8, v4, v148 row_newbcast:13 row_mask:0xf bank_mask:0xf
    v_dot2c_f32_bf16_dpp v9, v5, v148 row_newbcast:13 row_mask:0xf bank_mask:0xf
    v_dot2c_f32_bf16_dpp v10, v4, v149 row_newbcast:13 row_mask:0xf bank_mask:0xf
    v_dot2c_f32_bf16_dpp v11, v5, v149 row_newbcast:13 row_mask:0xf bank_mask:0xf
    v_dot2c_f32_bf16_dpp v12, v4, v150 row_newbcast:13 row_mask:0xf bank_mask:0xf
    v_dot2c_f32_bf16_dpp v13, v5, v150 row_newbcast:13 row_mask:0xf bank_mask:0xf
    v_dot2c_f32_bf16_dpp v14, v4, v151 row_newbcast:13 row_mask:0xf bank_mask:0xf
    v_dot2c_f32_bf16_dpp v15, v5, v151 row_newbcast:13 row_mask:0xf bank_mask:0xf
    buffer_load_dwordx4 v[84:87], v1, s[32:35], s101 offen offset:1024 nt
    s_waitcnt vmcnt(15)
    v_dot2c_f32_bf16_dpp v8, v4, v152 row_newbcast:14 row_mask:0xf bank_mask:0xf
    v_dot2c_f32_bf16_dpp v9, v5, v152 row_newbcast:14 row_mask:0xf bank_mask:0xf
    v_dot2c_f32_bf16_dpp v10, v4, v153 row_newbcast:14 row_mask:0xf bank_mask:0xf
    v_dot2c_f32_bf16_dpp v11, v5, v153 row_newbcast:14 row_mask:0xf bank_mask:0xf
    v_dot2c_f32_bf16_dpp v12, v4, v154 row_newbcast:14 row_mask:0xf bank_mask:0xf
    v_dot2c_f32_bf16_dpp v13, v5, v154 row_newbcast:14 row_mask:0xf bank_mask:0xf
    v_dot2c_f32_bf16_dpp v14, v4, v155 row_newbcast:14 row_mask:0xf bank_mask:0xf
    v_dot2c_f32_bf16_dpp v15, v5, v155 row_newbcast:14 row_mask:0xf bank_mask:0xf
    buffer_load_dwordx4 v[88:91], v1, s[32:35], s101 offen offset:2048 nt
    s_waitcnt vmcnt(15)
    v_dot2c_f32_bf16_dpp v8, v4, v156 row_newbcast:15 row_mask:0xf bank_mask:0xf
    v_dot2c_f32_bf16_dpp v9, v5, v156 row_newbcast:15 row_mask:0xf bank_mask:0xf
    v_dot2c_f32_bf16_dpp v10, v4, v157 row_newbcast:15 row_mask:0xf bank_mask:0xf
    v_dot2c_f32_bf16_dpp v11, v5, v157 row_newbcast:15 row_mask:0xf bank_mask:0xf
    v_dot2c_f32_bf16_dpp v12, v4, v158 row_newbcast:15 row_mask:0xf bank_mask:0xf
    v_dot2c_f32_bf16_dpp v13, v5, v158 row_newbcast:15 row_mask:0xf bank_mask:0xf
    v_dot2c_f32_bf16_dpp v14, v4, v159 row_newbcast:15 row_mask:0xf bank_mask:0xf
    v_dot2c_f32_bf16_dpp v15, v5, v159 row_newbcast:15 row_mask:0xf bank_mask:0xf
    buffer_load_dwordx4 v[92:95], v1, s[32:35], s101 offen offset:3072 nt
    s_branch L_loop16
L_last0_16:
    s_branch L_lastc
L_last1_16:
    s_branch L_lastc
L_lastc:
    s_lshl_b32 s98, s81, 17
    s_lshl_b32 s89, s80, 14
    s_add_u32 s98, s98, s89
    s_add_u32 s99, s98, 4096
    s_add_u32 s100, s98, 8192
    s_add_u32 s101, s98, 12288
    buffer_load_dwordx4 v[32:35], v1, s[44:47], s98 offen offset:0
    buffer_load_dwordx4 v[36:39], v1, s[44:47], s98 offen offset:1024
    buffer_load_dwordx4 v[40:43], v1, s[44:47], s98 offen offset:2048
    buffer_load_dwordx4 v[44:47], v1, s[44:47], s98 offen offset:3072
    buffer_load_dwordx4 v[48:51], v1, s[44:47], s99 offen offset:0
    buffer_load_dwordx4 v[52:55], v1, s[44:47], s99 offen offset:1024
    buffer_load_dwordx4 v[56:59], v1, s[44:47], s99 offen offset:2048
    buffer_load_dwordx4 v[60:63], v1, s[44:47], s99 offen offset:3072
    buffer_load_dwordx4 v[64:67], v1, s[44:47], s100 offen offset:0
    buffer_load_dwordx4 v[68:71], v1, s[44:47], s100 offen offset:1024
    buffer_load_dwordx4 v[72:75], v1, s[44:47], s100 offen offset:2048
    buffer_load_dwordx4 v[76:79], v1, s[44:47], s100 offen offset:3072
    buffer_load_dwordx4 v[80:83], v1, s[44:47], s101 offen offset:0
    buffer_load_dwordx4 v[84:87], v1, s[44:47], s101 offen offset:1024
    buffer_load_dwordx4 v[88:91], v1, s[44:47], s101 offen offset:2048
    buffer_load_dwordx4 v[92:95], v1, s[44:47], s101 offen offset:3072
    s_waitcnt vmcnt(31)
    v_dot2c_f32_bf16_dpp v8, v4, v96 row_newbcast:0 row_mask:0xf bank_mask:0xf
    v_dot2c_f32_bf16_dpp v9, v5, v96 row_newbcast:0 row_mask:0xf bank_mask:0xf
    v_dot2c_f32_bf16_dpp v10, v4, v97 row_newbcast:0 row_mask:0xf bank_mask:0xf
    v_dot2c_f32_bf16_dpp v11, v5, v97 row_newbcast:0 row_mask:0xf bank_mask:0xf
    v_dot2c_f32_bf16_dpp v12, v4, v98 row_newbcast:0 row_mask:0xf bank_mask:0xf
    v_dot2c_f32_bf16_dpp v13, v5, v98 row_newbcast:0 row_mask:0xf bank_mask:0xf
    v_dot2c_f32_bf16_dpp v14, v4, v99 row_newbcast:0 row_mask:0xf bank_mask:0xf
    v_dot2c_f32_bf16_dpp v15, v5, v99 row_newbcast:0 row_mask:0xf bank_mask:0xf
    s_waitcnt vmcnt(30)
    v_dot2c_f32_bf16_dpp v8, v4, v100 row_newbcast:1 row_mask:0xf bank_mask:0xf
    v_dot2c_f32_bf16_dpp v9, v5, v100 row_newbcast:1 row_mask:0xf bank_mask:0xf
    v_dot2c_f32_bf16_dpp v10, v4, v101 row_newbcast:1 row_mask:0xf bank_mask:0xf
    v_dot2c_f32_bf16_dpp v11, v5, v101 row_newbcast:1 row_mask:0xf bank_mask:0xf
    v_dot2c_f32_bf16_dpp v12, v4, v102 row_newbcast:1 row_mask:0xf bank_mask:0xf
    v_dot2c_f32_bf16_dpp v13, v5, v102 row_newbcast:1 row_mask:0xf bank_mask:0xf
    v_dot2c_f32_bf16_dpp v14, v4, v103 row_newbcast:1 row_mask:0xf bank_mask:0xf
    v_dot2c_f32_bf16_dpp v15, v5, v103 row_newbcast:1 row_mask:0xf bank_mask:0xf
    s_waitcnt vmcnt(29)
    v_dot2c_f32_bf16_dpp v8, v4, v104 row_newbcast:2 row_mask:0xf bank_mask:0xf
    v_dot2c_f32_bf16_dpp v9, v5, v104 row_newbcast:2 row_mask:0xf bank_mask:0xf
    v_dot2c_f32_bf16_dpp v10, v4, v105 row_newbcast:2 row_mask:0xf bank_mask:0xf
    v_dot2c_f32_bf16_dpp v11, v5, v105 row_newbcast:2 row_mask:0xf bank_mask:0xf
    v_dot2c_f32_bf16_dpp v12, v4, v106 row_newbcast:2 row_mask:0xf bank_mask:0xf
    v_dot2c_f32_bf16_dpp v13, v5, v106 row_newbcast:2 row_mask:0xf bank_mask:0xf
    v_dot2c_f32_bf16_dpp v14, v4, v107 row_newbcast:2 row_mask:0xf bank_mask:0xf
    v_dot2c_f32_bf16_dpp v15, v5, v107 row_newbcast:2 row_mask:0xf bank_mask:0xf
    s_waitcnt vmcnt(28)
    v_dot2c_f32_bf16_dpp v8, v4, v108 row_newbcast:3 row_mask:0xf bank_mask:0xf
    v_dot2c_f32_bf16_dpp v9, v5, v108 row_newbcast:3 row_mask:0xf bank_mask:0xf
    v_dot2c_f32_bf16_dpp v10, v4, v109 row_newbcast:3 row_mask:0xf bank_mask:0xf
    v_dot2c_f32_bf16_dpp v11, v5, v109 row_newbcast:3 row_mask:0xf bank_mask:0xf
    v_dot2c_f32_bf16_dpp v12, v4, v110 row_newbcast:3 row_mask:0xf bank_mask:0xf
    v_dot2c_f32_bf16_dpp v13, v5, v110 row_newbcast:3 row_mask:0xf bank_mask:0xf
    v_dot2c_f32_bf16_dpp v14, v4, v111 row_newbcast:3 row_mask:0xf bank_mask:0xf
    v_dot2c_f32_bf16_dpp v15, v5, v111 row_newbcast:3 row_mask:0xf bank_mask:0xf
    s_waitcnt vmcnt(27)
    v_dot2c_f32_bf16_dpp v8, v4, v112 row_newbcast:4 row_mask:0xf bank_mask:0xf
    v_dot2c_f32_bf16_dpp v9, v5, v112 row_newbcast:4 row_mask:0xf bank_mask:0xf
    v_dot2c_f32_bf16_dpp v10, v4, v113 row_newbcast:4 row_mask:0xf bank_mask:0xf
    v_dot2c_f32_bf16_dpp v11, v5, v113 row_newbcast:4 row_mask:0xf bank_mask:0xf
    v_dot2c_f32_bf16_dpp v12, v4, v114 row_newbcast:4 row_mask:0xf bank_mask:0xf
    v_dot2c_f32_bf16_dpp v13, v5, v114 row_newbcast:4 row_mask:0xf bank_mask:0xf
    v_dot2c_f32_bf16_dpp v14, v4, v115 row_newbcast:4 row_mask:0xf bank_mask:0xf
    v_dot2c_f32_bf16_dpp v15, v5, v115 row_newbcast:4 row_mask:0xf bank_mask:0xf
    s_waitcnt vmcnt(26)
    v_dot2c_f32_bf16_dpp v8, v4, v116 row_newbcast:5 row_mask:0xf bank_mask:0xf
    v_dot2c_f32_bf16_dpp v9, v5, v116 row_newbcast:5 row_mask:0xf bank_mask:0xf
    v_dot2c_f32_bf16_dpp v10, v4, v117 row_newbcast:5 row_mask:0xf bank_mask:0xf
    v_dot2c_f32_bf16_dpp v11, v5, v117 row_newbcast:5 row_mask:0xf bank_mask:0xf
    v_dot2c_f32_bf16_dpp v12, v4, v118 row_newbcast:5 row_mask:0xf bank_mask:0xf
    v_dot2c_f32_bf16_dpp v13, v5, v118 row_newbcast:5 row_mask:0xf bank_mask:0xf
    v_dot2c_f32_bf16_dpp v14, v4, v119 row_newbcast:5 row_mask:0xf bank_mask:0xf
    v_dot2c_f32_bf16_dpp v15, v5, v119 row_newbcast:5 row_mask:0xf bank_mask:0xf
    s_waitcnt vmcnt(25)
    v_dot2c_f32_bf16_dpp v8, v4, v120 row_newbcast:6 row_mask:0xf bank_mask:0xf
    v_dot2c_f32_bf16_dpp v9, v5, v120 row_newbcast:6 row_mask:0xf bank_mask:0xf
    v_dot2c_f32_bf16_dpp v10, v4, v121 row_newbcast:6 row_mask:0xf bank_mask:0xf
    v_dot2c_f32_bf16_dpp v11, v5, v121 row_newbcast:6 row_mask:0xf bank_mask:0xf
    v_dot2c_f32_bf16_dpp v12, v4, v122 row_newbcast:6 row_mask:0xf bank_mask:0xf
    v_dot2c_f32_bf16_dpp v13, v5, v122 row_newbcast:6 row_mask:0xf bank_mask:0xf
    v_dot2c_f32_bf16_dpp v14, v4, v123 row_newbcast:6 row_mask:0xf bank_mask:0xf
    v_dot2c_f32_bf16_dpp v15, v5, v123 row_newbcast:6 row_mask:0xf bank_mask:0xf
    s_waitcnt vmcnt(24)
    v_dot2c_f32_bf16_dpp v8, v4, v124 row_newbcast:7 row_mask:0xf bank_mask:0xf
    v_dot2c_f32_bf16_dpp v9, v5, v124 row_newbcast:7 row_mask:0xf bank_mask:0xf
    v_dot2c_f32_bf16_dpp v10, v4, v125 row_newbcast:7 row_mask:0xf bank_mask:0xf
    v_dot2c_f32_bf16_dpp v11, v5, v125 row_newbcast:7 row_mask:0xf bank_mask:0xf
    v_dot2c_f32_bf16_dpp v12, v4, v126 row_newbcast:7 row_mask:0xf bank_mask:0xf
    v_dot2c_f32_bf16_dpp v13, v5, v126 row_newbcast:7 row_mask:0xf bank_mask:0xf
    v_dot2c_f32_bf16_dpp v14, v4, v127 row_newbcast:7 row_mask:0xf bank_mask:0xf
    v_dot2c_f32_bf16_dpp v15, v5, v127 row_newbcast:7 row_mask:0xf bank_mask:0xf
    s_waitcnt vmcnt(23)
    v_dot2c_f32_bf16_dpp v8, v4, v128 row_newbcast:8 row_mask:0xf bank_mask:0xf
    v_dot2c_f32_bf16_dpp v9, v5, v128 row_newbcast:8 row_mask:0xf bank_mask:0xf
    v_dot2c_f32_bf16_dpp v10, v4, v129 row_newbcast:8 row_mask:0xf bank_mask:0xf
    v_dot2c_f32_bf16_dpp v11, v5, v129 row_newbcast:8 row_mask:0xf bank_mask:0xf
    v_dot2c_f32_bf16_dpp v12, v4, v130 row_newbcast:8 row_mask:0xf bank_mask:0xf
    v_dot2c_f32_bf16_dpp v13, v5, v130 row_newbcast:8 row_mask:0xf bank_mask:0xf
    v_dot2c_f32_bf16_dpp v14, v4, v131 row_newbcast:8 row_mask:0xf bank_mask:0xf
    v_dot2c_f32_bf16_dpp v15, v5, v131 row_newbcast:8 row_mask:0xf bank_mask:0xf
    s_waitcnt vmcnt(22)
    v_dot2c_f32_bf16_dpp v8, v4, v132 row_newbcast:9 row_mask:0xf bank_mask:0xf
    v_dot2c_f32_bf16_dpp v9, v5, v132 row_newbcast:9 row_mask:0xf bank_mask:0xf
    v_dot2c_f32_bf16_dpp v10, v4, v133 row_newbcast:9 row_mask:0xf bank_mask:0xf
    v_dot2c_f32_bf16_dpp v11, v5, v133 row_newbcast:9 row_mask:0xf bank_mask:0xf
    v_dot2c_f32_bf16_dpp v12, v4, v134 row_newbcast:9 row_mask:0xf bank_mask:0xf
    v_dot2c_f32_bf16_dpp v13, v5, v134 row_newbcast:9 row_mask:0xf bank_mask:0xf
    v_dot2c_f32_bf16_dpp v14, v4, v135 row_newbcast:9 row_mask:0xf bank_mask:0xf
    v_dot2c_f32_bf16_dpp v15, v5, v135 row_newbcast:9 row_mask:0xf bank_mask:0xf
    s_waitcnt vmcnt(21)
    v_dot2c_f32_bf16_dpp v8, v4, v136 row_newbcast:10 row_mask:0xf bank_mask:0xf
    v_dot2c_f32_bf16_dpp v9, v5, v136 row_newbcast:10 row_mask:0xf bank_mask:0xf
    v_dot2c_f32_bf16_dpp v10, v4, v137 row_newbcast:10 row_mask:0xf bank_mask:0xf
    v_dot2c_f32_bf16_dpp v11, v5, v137 row_newbcast:10 row_mask:0xf bank_mask:0xf
    v_dot2c_f32_bf16_dpp v12, v4, v138 row_newbcast:10 row_mask:0xf bank_mask:0xf
    v_dot2c_f32_bf16_dpp v13, v5, v138 row_newbcast:10 row_mask:0xf bank_mask:0xf
    v_dot2c_f32_bf16_dpp v14, v4, v139 row_newbcast:10 row_mask:0xf bank_mask:0xf
    v_dot2c_f32_bf16_dpp v15, v5, v139 row_newbcast:10 row_mask:0xf bank_mask:0xf
    s_waitcnt vmcnt(20)
    v_dot2c_f32_bf16_dpp v8, v4, v140 row_newbcast:11 row_mask:0xf bank_mask:0xf
    v_dot2c_f32_bf16_dpp v9, v5, v140 row_newbcast:11 row_mask:0xf bank_mask:0xf
    v_dot2c_f32_bf16_dpp v10, v4, v141 row_newbcast:11 row_mask:0xf bank_mask:0xf
    v_dot2c_f32_bf16_dpp v11, v5, v141 row_newbcast:11 row_mask:0xf bank_mask:0xf
    v_dot2c_f32_bf16_dpp v12, v4, v142 row_newbcast:11 row_mask:0xf bank_mask:0xf
    v_dot2c_f32_bf16_dpp v13, v5, v142 row_newbcast:11 row_mask:0xf bank_mask:0xf
    v_dot2c_f32_bf16_dpp v14, v4, v143 row_newbcast:11 row_mask:0xf bank_mask:0xf
    v_dot2c_f32_bf16_dpp v15, v5, v143 row_newbcast:11 row_mask:0xf bank_mask:0xf
    s_waitcnt vmcnt(19)
    v_dot2c_f32_bf16_dpp v8, v4, v144 row_newbcast:12 row_mask:0xf bank_mask:0xf
    v_dot2c_f32_bf16_dpp v9, v5, v144 row_newbcast:12 row_mask:0xf bank_mask:0xf
    v_dot2c_f32_bf16_dpp v10, v4, v145 row_newbcast:12 row_mask:0xf bank_mask:0xf
    v_dot2c_f32_bf16_dpp v11, v5, v145 row_newbcast:12 row_mask:0xf bank_mask:0xf
    v_dot2c_f32_bf16_dpp v12, v4, v146 row_newbcast:12 row_mask:0xf bank_mask:0xf
    v_dot2c_f32_bf16_dpp v13, v5, v146 row_newbcast:12 row_mask:0xf bank_mask:0xf
    v_dot2c_f32_bf16_dpp v14, v4, v147 row_newbcast:12 row_mask:0xf bank_mask:0xf
    v_dot2c_f32_bf16_dpp v15, v5, v147 row_newbcast:12 row_mask:0xf bank_mask:0xf
    s_waitcnt vmcnt(18)
    v_dot2c_f32_bf16_dpp v8, v4, v148 row_newbcast:13 row_mask:0xf bank_mask:0xf
    v_dot2c_f32_bf16_dpp v9, v5, v148 row_newbcast:13 row_mask:0xf bank_mask:0xf
    v_dot2c_f32_bf16_dpp v10, v4, v149 row_newbcast:13 row_mask:0xf bank_mask:0xf
    v_dot2c_f32_bf16_dpp v11, v5, v149 row_newbcast:13 row_mask:0xf bank_mask:0xf
    v_dot2c_f32_bf16_dpp v12, v4, v150 row_newbcast:13 row_mask:0xf bank_mask:0xf
    v_dot2c_f32_bf16_dpp v13, v5, v150 row_newbcast:13 row_mask:0xf bank_mask:0xf
    v_dot2c_f32_bf16_dpp v14, v4, v151 row_newbcast:13 row_mask:0xf bank_mask:0xf
    v_dot2c_f32_bf16_dpp v15, v5, v151 row_newbcast:13 row_mask:0xf bank_mask:0xf
    s_waitcnt vmcnt(17)
    v_dot2c_f32_bf16_dpp v8, v4, v152 row_newbcast:14 row_mask:0xf bank_mask:0xf
    v_dot2c_f32_bf16_dpp v9, v5, v152 row_newbcast:14 row_mask:0xf bank_mask:0xf
    v_dot2c_f32_bf16_dpp v10, v4, v153 row_newbcast:14 row_mask:0xf bank_mask:0xf
    v_dot2c_f32_bf16_dpp v11, v5, v153 row_newbcast:14 row_mask:0xf bank_mask:0xf
    v_dot2c_f32_bf16_dpp v12, v4, v154 row_newbcast:14 row_mask:0xf bank_mask:0xf
    v_dot2c_f32_bf16_dpp v13, v5, v154 row_newbcast:14 row_mask:0xf bank_mask:0xf
    v_dot2c_f32_bf16_dpp v14, v4, v155 row_newbcast:14 row_mask:0xf bank_mask:0xf
    v_dot2c_f32_bf16_dpp v15, v5, v155 row_newbcast:14 row_mask:0xf bank_mask:0xf
    s_waitcnt vmcnt(16)
    v_dot2c_f32_bf16_dpp v8, v4, v156 row_newbcast:15 row_mask:0xf bank_mask:0xf
    v_dot2c_f32_bf16_dpp v9, v5, v156 row_newbcast:15 row_mask:0xf bank_mask:0xf
    v_dot2c_f32_bf16_dpp v10, v4, v157 row_newbcast:15 row_mask:0xf bank_mask:0xf
    v_dot2c_f32_bf16_dpp v11, v5, v157 row_newbcast:15 row_mask:0xf bank_mask:0xf
    v_dot2c_f32_bf16_dpp v12, v4, v158 row_newbcast:15 row_mask:0xf bank_mask:0xf
    v_dot2c_f32_bf16_dpp v13, v5, v158 row_newbcast:15 row_mask:0xf bank_mask:0xf
    v_dot2c_f32_bf16_dpp v14, v4, v159 row_newbcast:15 row_mask:0xf bank_mask:0xf
    v_dot2c_f32_bf16_dpp v15, v5, v159 row_newbcast:15 row_mask:0xf bank_mask:0xf
    v_mov_b32 v6, v2
    v_mov_b32 v7, v6
    s_nop 1
    v_permlane32_swap_b32 v6, v7
    v_max_f32 v6, v6, v7
    v_mov_b32 v7, v6
    s_nop 1
    v_permlane16_swap_b32 v6, v7
    v_max_f32 v6, v6, v7
    v_sub_f32 v7, v2, v6
    v_exp_f32 v7, v7
    s_nop 0
    v_mul_f32 v3, v3, v7
    v_mul_f32 v8, v8, v7
    v_mul_f32 v9, v9, v7
    v_mul_f32 v10, v10, v7
    v_mul_f32 v11, v11, v7
    v_mul_f32 v12, v12, v7
    v_mul_f32 v13, v13, v7
    v_mul_f32 v14, v14, v7
    v_mul_f32 v15, v15, v7
    s_nop 1
    v_add_f32_dpp v3, v3, v3 row_mirror row_mask:0xf bank_mask:0xf
    s_nop 1
    v_add_f32_dpp v3, v3, v3 row_half_mirror row_mask:0xf bank_mask:0xf
    s_nop 1
    v_add_f32_dpp v3, v3, v3 quad_perm:[3,2,1,0] row_mask:0xf bank_mask:0xf
    s_nop 1
    v_add_f32_dpp v3, v3, v3 quad_perm:[1,0,3,2] row_mask:0xf bank_mask:0xf
    v_mov_b32 v7, v3
    s_nop 1
    v_permlane32_swap_b32 v3, v7
    v_add_f32 v3, v3, v7
    v_mov_b32 v7, v3
    s_nop 1
    v_permlane16_swap_b32 v3, v7
    v_add_f32 v3, v3, v7
    s_nop 2
    v_permlane32_swap_b32 v8, v12
    v_permlane32_swap_b32 v9, v13
    v_permlane32_swap_b32 v10, v14
    v_permlane32_swap_b32 v11, v15
    v_add_f32 v8, v8, v12
    v_add_f32 v9, v9, v13
    v_add_f32 v10, v10, v14
    v_add_f32 v11, v11, v15
    s_nop 1
    v_permlane16_swap_b32 v8, v10
    v_permlane16_swap_b32 v9, v11
    v_add_f32 v8, v8, v10
    v_add_f32 v9, v9, v11
    v_mov_b32 v7, v3
    ds_write_b64 v160, v[8:9] offset:6144
    s_lshl_b32 s89, s80, 3
    v_mov_b32 v28, s89
    ds_write_b64 v28, v[6:7] offset:10240
    s_lshl_b32 s89, s80, 6
    v_lshl_add_u32 v29, v161, 2, s89
    v_mov_b32 v30, 0
    s_waitcnt lgkmcnt(0)
    s_barrier
    ds_read_b128 v[96:99], v30 offset:10240
    ds_read_b128 v[100:103], v30 offset:10256
    ds_read_b128 v[104:107], v30 offset:10272
    ds_read_b128 v[108:111], v30 offset:10288
    ds_read_b32 v112, v29 offset:6144
    ds_read_b32 v113, v29 offset:6656
    ds_read_b32 v114, v29 offset:7168
    ds_read_b32 v115, v29 offset:7680
    ds_read_b32 v116, v29 offset:8192
    ds_read_b32 v117, v29 offset:8704
    ds_read_b32 v118, v29 offset:9216
    ds_read_b32 v119, v29 offset:9728
    s_waitcnt lgkmcnt(8)
    v_max3_f32 v2, v96, v98, v100
    v_max3_f32 v2, v2, v102, v104
    v_max3_f32 v2, v2, v106, v108
    v_max_f32 v2, v2, v110
    v_sub_f32 v96, v96, v2
    v_sub_f32 v98, v98, v2
    v_sub_f32 v100, v100, v2
    v_sub_f32 v102, v102, v2
    v_sub_f32 v104, v104, v2
    v_sub_f32 v106, v106, v2
    v_sub_f32 v108, v108, v2
    v_sub_f32 v110, v110, v2
    v_exp_f32 v96, v96
    v_exp_f32 v98, v98
    v_exp_f32 v100, v100
    v_exp_f32 v102, v102
    v_exp_f32 v104, v104
    v_exp_f32 v106, v106
    v_exp_f32 v108, v108
    v_exp_f32 v110, v110
    s_waitcnt lgkmcnt(0)
    v_mul_f32 v3, v96, v97
    v_mul_f32 v6, v96, v112
    v_fmac_f32 v3, v98, v99
    v_fmac_f32 v6, v98, v113
    v_fmac_f32 v3, v100, v101
    v_fmac_f32 v6, v100, v114
    v_fmac_f32 v3, v102, v103
    v_fmac_f32 v6, v102, v115
    v_fmac_f32 v3, v104, v105
    v_fmac_f32 v6, v104, v116
    v_fmac_f32 v3, v106, v107
    v_fmac_f32 v6, v106, v117
    v_fmac_f32 v3, v108, v109
    v_fmac_f32 v6, v108, v118
    v_fmac_f32 v3, v110, v111
    v_fmac_f32 v6, v110, v119
    v_cvt_pk_bf16_f32 v4, v6, 0
    v_cvt_pk_bf16_f32 v5, 0, v6
    v_mov_b32 v8, 0
    v_mov_b32 v9, 0
    v_mov_b32 v10, 0
    v_mov_b32 v11, 0
    v_mov_b32 v12, 0
    v_mov_b32 v13, 0
    v_mov_b32 v14, 0
    v_mov_b32 v15, 0
    s_waitcnt vmcnt(15)
    v_dot2c_f32_bf16_dpp v8, v4, v32 row_newbcast:0 row_mask:0xf bank_mask:0xf
    v_dot2c_f32_bf16_dpp v9, v5, v32 row_newbcast:0 row_mask:0xf bank_mask:0xf
    v_dot2c_f32_bf16_dpp v10, v4, v33 row_newbcast:0 row_mask:0xf bank_mask:0xf
    v_dot2c_f32_bf16_dpp v11, v5, v33 row_newbcast:0 row_mask:0xf bank_mask:0xf
    v_dot2c_f32_bf16_dpp v12, v4, v34 row_newbcast:0 row_mask:0xf bank_mask:0xf
    v_dot2c_f32_bf16_dpp v13, v5, v34 row_newbcast:0 row_mask:0xf bank_mask:0xf
    v_dot2c_f32_bf16_dpp v14, v4, v35 row_newbcast:0 row_mask:0xf bank_mask:0xf
    v_dot2c_f32_bf16_dpp v15, v5, v35 row_newbcast:0 row_mask:0xf bank_mask:0xf
    s_waitcnt vmcnt(14)
    v_dot2c_f32_bf16_dpp v8, v4, v36 row_newbcast:1 row_mask:0xf bank_mask:0xf
    v_dot2c_f32_bf16_dpp v9, v5, v36 row_newbcast:1 row_mask:0xf bank_mask:0xf
    v_dot2c_f32_bf16_dpp v10, v4, v37 row_newbcast:1 row_mask:0xf bank_mask:0xf
    v_dot2c_f32_bf16_dpp v11, v5, v37 row_newbcast:1 row_mask:0xf bank_mask:0xf
    v_dot2c_f32_bf16_dpp v12, v4, v38 row_newbcast:1 row_mask:0xf bank_mask:0xf
    v_dot2c_f32_bf16_dpp v13, v5, v38 row_newbcast:1 row_mask:0xf bank_mask:0xf
    v_dot2c_f32_bf16_dpp v14, v4, v39 row_newbcast:1 row_mask:0xf bank_mask:0xf
    v_dot2c_f32_bf16_dpp v15, v5, v39 row_newbcast:1 row_mask:0xf bank_mask:0xf
    s_waitcnt vmcnt(13)
    v_dot2c_f32_bf16_dpp v8, v4, v40 row_newbcast:2 row_mask:0xf bank_mask:0xf
    v_dot2c_f32_bf16_dpp v9, v5, v40 row_newbcast:2 row_mask:0xf bank_mask:0xf
    v_dot2c_f32_bf16_dpp v10, v4, v41 row_newbcast:2 row_mask:0xf bank_mask:0xf
    v_dot2c_f32_bf16_dpp v11, v5, v41 row_newbcast:2 row_mask:0xf bank_mask:0xf
    v_dot2c_f32_bf16_dpp v12, v4, v42 row_newbcast:2 row_mask:0xf bank_mask:0xf
    v_dot2c_f32_bf16_dpp v13, v5, v42 row_newbcast:2 row_mask:0xf bank_mask:0xf
    v_dot2c_f32_bf16_dpp v14, v4, v43 row_newbcast:2 row_mask:0xf bank_mask:0xf
    v_dot2c_f32_bf16_dpp v15, v5, v43 row_newbcast:2 row_mask:0xf bank_mask:0xf
    s_waitcnt vmcnt(12)
    v_dot2c_f32_bf16_dpp v8, v4, v44 row_newbcast:3 row_mask:0xf bank_mask:0xf
    v_dot2c_f32_bf16_dpp v9, v5, v44 row_newbcast:3 row_mask:0xf bank_mask:0xf
    v_dot2c_f32_bf16_dpp v10, v4, v45 row_newbcast:3 row_mask:0xf bank_mask:0xf
    v_dot2c_f32_bf16_dpp v11, v5, v45 row_newbcast:3 row_mask:0xf bank_mask:0xf
    v_dot2c_f32_bf16_dpp v12, v4, v46 row_newbcast:3 row_mask:0xf bank_mask:0xf
    v_dot2c_f32_bf16_dpp v13, v5, v46 row_newbcast:3 row_mask:0xf bank_mask:0xf
    v_dot2c_f32_bf16_dpp v14, v4, v47 row_newbcast:3 row_mask:0xf bank_mask:0xf
    v_dot2c_f32_bf16_dpp v15, v5, v47 row_newbcast:3 row_mask:0xf bank_mask:0xf
    s_waitcnt vmcnt(11)
    v_dot2c_f32_bf16_dpp v8, v4, v48 row_newbcast:4 row_mask:0xf bank_mask:0xf
    v_dot2c_f32_bf16_dpp v9, v5, v48 row_newbcast:4 row_mask:0xf bank_mask:0xf
    v_dot2c_f32_bf16_dpp v10, v4, v49 row_newbcast:4 row_mask:0xf bank_mask:0xf
    v_dot2c_f32_bf16_dpp v11, v5, v49 row_newbcast:4 row_mask:0xf bank_mask:0xf
    v_dot2c_f32_bf16_dpp v12, v4, v50 row_newbcast:4 row_mask:0xf bank_mask:0xf
    v_dot2c_f32_bf16_dpp v13, v5, v50 row_newbcast:4 row_mask:0xf bank_mask:0xf
    v_dot2c_f32_bf16_dpp v14, v4, v51 row_newbcast:4 row_mask:0xf bank_mask:0xf
    v_dot2c_f32_bf16_dpp v15, v5, v51 row_newbcast:4 row_mask:0xf bank_mask:0xf
    s_waitcnt vmcnt(10)
    v_dot2c_f32_bf16_dpp v8, v4, v52 row_newbcast:5 row_mask:0xf bank_mask:0xf
    v_dot2c_f32_bf16_dpp v9, v5, v52 row_newbcast:5 row_mask:0xf bank_mask:0xf
    v_dot2c_f32_bf16_dpp v10, v4, v53 row_newbcast:5 row_mask:0xf bank_mask:0xf
    v_dot2c_f32_bf16_dpp v11, v5, v53 row_newbcast:5 row_mask:0xf bank_mask:0xf
    v_dot2c_f32_bf16_dpp v12, v4, v54 row_newbcast:5 row_mask:0xf bank_mask:0xf
    v_dot2c_f32_bf16_dpp v13, v5, v54 row_newbcast:5 row_mask:0xf bank_mask:0xf
    v_dot2c_f32_bf16_dpp v14, v4, v55 row_newbcast:5 row_mask:0xf bank_mask:0xf
    v_dot2c_f32_bf16_dpp v15, v5, v55 row_newbcast:5 row_mask:0xf bank_mask:0xf
    s_waitcnt vmcnt(9)
    v_dot2c_f32_bf16_dpp v8, v4, v56 row_newbcast:6 row_mask:0xf bank_mask:0xf
    v_dot2c_f32_bf16_dpp v9, v5, v56 row_newbcast:6 row_mask:0xf bank_mask:0xf
    v_dot2c_f32_bf16_dpp v10, v4, v57 row_newbcast:6 row_mask:0xf bank_mask:0xf
    v_dot2c_f32_bf16_dpp v11, v5, v57 row_newbcast:6 row_mask:0xf bank_mask:0xf
    v_dot2c_f32_bf16_dpp v12, v4, v58 row_newbcast:6 row_mask:0xf bank_mask:0xf
    v_dot2c_f32_bf16_dpp v13, v5, v58 row_newbcast:6 row_mask:0xf bank_mask:0xf
    v_dot2c_f32_bf16_dpp v14, v4, v59 row_newbcast:6 row_mask:0xf bank_mask:0xf
    v_dot2c_f32_bf16_dpp v15, v5, v59 row_newbcast:6 row_mask:0xf bank_mask:0xf
    s_waitcnt vmcnt(8)
    v_dot2c_f32_bf16_dpp v8, v4, v60 row_newbcast:7 row_mask:0xf bank_mask:0xf
    v_dot2c_f32_bf16_dpp v9, v5, v60 row_newbcast:7 row_mask:0xf bank_mask:0xf
    v_dot2c_f32_bf16_dpp v10, v4, v61 row_newbcast:7 row_mask:0xf bank_mask:0xf
    v_dot2c_f32_bf16_dpp v11, v5, v61 row_newbcast:7 row_mask:0xf bank_mask:0xf
    v_dot2c_f32_bf16_dpp v12, v4, v62 row_newbcast:7 row_mask:0xf bank_mask:0xf
    v_dot2c_f32_bf16_dpp v13, v5, v62 row_newbcast:7 row_mask:0xf bank_mask:0xf
    v_dot2c_f32_bf16_dpp v14, v4, v63 row_newbcast:7 row_mask:0xf bank_mask:0xf
    v_dot2c_f32_bf16_dpp v15, v5, v63 row_newbcast:7 row_mask:0xf bank_mask:0xf
    s_waitcnt vmcnt(7)
    v_dot2c_f32_bf16_dpp v8, v4, v64 row_newbcast:8 row_mask:0xf bank_mask:0xf
    v_dot2c_f32_bf16_dpp v9, v5, v64 row_newbcast:8 row_mask:0xf bank_mask:0xf
    v_dot2c_f32_bf16_dpp v10, v4, v65 row_newbcast:8 row_mask:0xf bank_mask:0xf
    v_dot2c_f32_bf16_dpp v11, v5, v65 row_newbcast:8 row_mask:0xf bank_mask:0xf
    v_dot2c_f32_bf16_dpp v12, v4, v66 row_newbcast:8 row_mask:0xf bank_mask:0xf
    v_dot2c_f32_bf16_dpp v13, v5, v66 row_newbcast:8 row_mask:0xf bank_mask:0xf
    v_dot2c_f32_bf16_dpp v14, v4, v67 row_newbcast:8 row_mask:0xf bank_mask:0xf
    v_dot2c_f32_bf16_dpp v15, v5, v67 row_newbcast:8 row_mask:0xf bank_mask:0xf
    s_waitcnt vmcnt(6)
    v_dot2c_f32_bf16_dpp v8, v4, v68 row_newbcast:9 row_mask:0xf bank_mask:0xf
    v_dot2c_f32_bf16_dpp v9, v5, v68 row_newbcast:9 row_mask:0xf bank_mask:0xf
    v_dot2c_f32_bf16_dpp v10, v4, v69 row_newbcast:9 row_mask:0xf bank_mask:0xf
    v_dot2c_f32_bf16_dpp v11, v5, v69 row_newbcast:9 row_mask:0xf bank_mask:0xf
    v_dot2c_f32_bf16_dpp v12, v4, v70 row_newbcast:9 row_mask:0xf bank_mask:0xf
    v_dot2c_f32_bf16_dpp v13, v5, v70 row_newbcast:9 row_mask:0xf bank_mask:0xf
    v_dot2c_f32_bf16_dpp v14, v4, v71 row_newbcast:9 row_mask:0xf bank_mask:0xf
    v_dot2c_f32_bf16_dpp v15, v5, v71 row_newbcast:9 row_mask:0xf bank_mask:0xf
    s_waitcnt vmcnt(5)
    v_dot2c_f32_bf16_dpp v8, v4, v72 row_newbcast:10 row_mask:0xf bank_mask:0xf
    v_dot2c_f32_bf16_dpp v9, v5, v72 row_newbcast:10 row_mask:0xf bank_mask:0xf
    v_dot2c_f32_bf16_dpp v10, v4, v73 row_newbcast:10 row_mask:0xf bank_mask:0xf
    v_dot2c_f32_bf16_dpp v11, v5, v73 row_newbcast:10 row_mask:0xf bank_mask:0xf
    v_dot2c_f32_bf16_dpp v12, v4, v74 row_newbcast:10 row_mask:0xf bank_mask:0xf
    v_dot2c_f32_bf16_dpp v13, v5, v74 row_newbcast:10 row_mask:0xf bank_mask:0xf
    v_dot2c_f32_bf16_dpp v14, v4, v75 row_newbcast:10 row_mask:0xf bank_mask:0xf
    v_dot2c_f32_bf16_dpp v15, v5, v75 row_newbcast:10 row_mask:0xf bank_mask:0xf
    s_waitcnt vmcnt(4)
    v_dot2c_f32_bf16_dpp v8, v4, v76 row_newbcast:11 row_mask:0xf bank_mask:0xf
    v_dot2c_f32_bf16_dpp v9, v5, v76 row_newbcast:11 row_mask:0xf bank_mask:0xf
    v_dot2c_f32_bf16_dpp v10, v4, v77 row_newbcast:11 row_mask:0xf bank_mask:0xf
    v_dot2c_f32_bf16_dpp v11, v5, v77 row_newbcast:11 row_mask:0xf bank_mask:0xf
    v_dot2c_f32_bf16_dpp v12, v4, v78 row_newbcast:11 row_mask:0xf bank_mask:0xf
    v_dot2c_f32_bf16_dpp v13, v5, v78 row_newbcast:11 row_mask:0xf bank_mask:0xf
    v_dot2c_f32_bf16_dpp v14, v4, v79 row_newbcast:11 row_mask:0xf bank_mask:0xf
    v_dot2c_f32_bf16_dpp v15, v5, v79 row_newbcast:11 row_mask:0xf bank_mask:0xf
    s_waitcnt vmcnt(3)
    v_dot2c_f32_bf16_dpp v8, v4, v80 row_newbcast:12 row_mask:0xf bank_mask:0xf
    v_dot2c_f32_bf16_dpp v9, v5, v80 row_newbcast:12 row_mask:0xf bank_mask:0xf
    v_dot2c_f32_bf16_dpp v10, v4, v81 row_newbcast:12 row_mask:0xf bank_mask:0xf
    v_dot2c_f32_bf16_dpp v11, v5, v81 row_newbcast:12 row_mask:0xf bank_mask:0xf
    v_dot2c_f32_bf16_dpp v12, v4, v82 row_newbcast:12 row_mask:0xf bank_mask:0xf
    v_dot2c_f32_bf16_dpp v13, v5, v82 row_newbcast:12 row_mask:0xf bank_mask:0xf
    v_dot2c_f32_bf16_dpp v14, v4, v83 row_newbcast:12 row_mask:0xf bank_mask:0xf
    v_dot2c_f32_bf16_dpp v15, v5, v83 row_newbcast:12 row_mask:0xf bank_mask:0xf
    s_waitcnt vmcnt(2)
    v_dot2c_f32_bf16_dpp v8, v4, v84 row_newbcast:13 row_mask:0xf bank_mask:0xf
    v_dot2c_f32_bf16_dpp v9, v5, v84 row_newbcast:13 row_mask:0xf bank_mask:0xf
    v_dot2c_f32_bf16_dpp v10, v4, v85 row_newbcast:13 row_mask:0xf bank_mask:0xf
    v_dot2c_f32_bf16_dpp v11, v5, v85 row_newbcast:13 row_mask:0xf bank_mask:0xf
    v_dot2c_f32_bf16_dpp v12, v4, v86 row_newbcast:13 row_mask:0xf bank_mask:0xf
    v_dot2c_f32_bf16_dpp v13, v5, v86 row_newbcast:13 row_mask:0xf bank_mask:0xf
    v_dot2c_f32_bf16_dpp v14, v4, v87 row_newbcast:13 row_mask:0xf bank_mask:0xf
    v_dot2c_f32_bf16_dpp v15, v5, v87 row_newbcast:13 row_mask:0xf bank_mask:0xf
    s_waitcnt vmcnt(1)
    v_dot2c_f32_bf16_dpp v8, v4, v88 row_newbcast:14 row_mask:0xf bank_mask:0xf
    v_dot2c_f32_bf16_dpp v9, v5, v88 row_newbcast:14 row_mask:0xf bank_mask:0xf
    v_dot2c_f32_bf16_dpp v10, v4, v89 row_newbcast:14 row_mask:0xf bank_mask:0xf
    v_dot2c_f32_bf16_dpp v11, v5, v89 row_newbcast:14 row_mask:0xf bank_mask:0xf
    v_dot2c_f32_bf16_dpp v12, v4, v90 row_newbcast:14 row_mask:0xf bank_mask:0xf
    v_dot2c_f32_bf16_dpp v13, v5, v90 row_newbcast:14 row_mask:0xf bank_mask:0xf
    v_dot2c_f32_bf16_dpp v14, v4, v91 row_newbcast:14 row_mask:0xf bank_mask:0xf
    v_dot2c_f32_bf16_dpp v15, v5, v91 row_newbcast:14 row_mask:0xf bank_mask:0xf
    s_waitcnt vmcnt(0)
    v_dot2c_f32_bf16_dpp v8, v4, v92 row_newbcast:15 row_mask:0xf bank_mask:0xf
    v_dot2c_f32_bf16_dpp v9, v5, v92 row_newbcast:15 row_mask:0xf bank_mask:0xf
    v_dot2c_f32_bf16_dpp v10, v4, v93 row_newbcast:15 row_mask:0xf bank_mask:0xf
    v_dot2c_f32_bf16_dpp v11, v5, v93 row_newbcast:15 row_mask:0xf bank_mask:0xf
    v_dot2c_f32_bf16_dpp v12, v4, v94 row_newbcast:15 row_mask:0xf bank_mask:0xf
    v_dot2c_f32_bf16_dpp v13, v5, v94 row_newbcast:15 row_mask:0xf bank_mask:0xf
    v_dot2c_f32_bf16_dpp v14, v4, v95 row_newbcast:15 row_mask:0xf bank_mask:0xf
    v_dot2c_f32_bf16_dpp v15, v5, v95 row_newbcast:15 row_mask:0xf bank_mask:0xf
    s_lshl_b32 s89, s80, 11
    v_add_u32 v28, s89, v1
    s_nop 1
    ds_write_b128 v28, v[8:11] offset:12416
    ds_write_b128 v28, v[12:15] offset:13440
    s_waitcnt lgkmcnt(0)
    s_barrier
    s_cmp_lg_u32 s80, 0
    s_cbranch_scc1 L_wait_ticket
    ds_read_b128 v[32:35], v1 offset:12416
    ds_read_b128 v[36:39], v1 offset:13440
    ds_read_b128 v[40:43], v1 offset:14464
    ds_read_b128 v[44:47], v1 offset:15488
    ds_read_b128 v[48:51], v1 offset:16512
    ds_read_b128 v[52:55], v1 offset:17536
    ds_read_b128 v[56:59], v1 offset:18560
    ds_read_b128 v[60:63], v1 offset:19584
    ds_read_b128 v[64:67], v1 offset:20608
    ds_read_b128 v[68:71], v1 offset:21632
    ds_read_b128 v[72:75], v1 offset:22656
    ds_read_b128 v[76:79], v1 offset:23680
    ds_read_b128 v[80:83], v1 offset:24704
    ds_read_b128 v[84:87], v1 offset:25728
    s_waitcnt lgkmcnt(8)
    ds_read_b128 v[88:91], v1 offset:26752
    ds_read_b128 v[92:95], v1 offset:27776
    ds_read_b32 v104, v30 offset:12352
    v_rcp_f32 v6, v3
    v_log_f32 v7, v3
    s_lshl_b32 s89, s82, 6
    s_lshl_b32 s91, s81, 1
    s_add_u32 s89, s89, s91
    s_add_u32 s89, s89, s83
    s_lshl_b32 s91, s89, 11
    s_lshl_b32 s96, s89, 2
    s_add_u32 s96, s96, 0x80000
    v_add_f32 v7, v7, v2
    s_waitcnt lgkmcnt(0)
    v_add_f32 v32, v32, v64
    v_add_f32 v33, v33, v65
    v_add_f32 v34, v34, v66
    v_add_f32 v35, v35, v67
    v_add_f32 v36, v36, v68
    v_add_f32 v37, v37, v69
    v_add_f32 v38, v38, v70
    v_add_f32 v39, v39, v71
    v_add_f32 v40, v40, v72
    v_add_f32 v41, v41, v73
    v_add_f32 v42, v42, v74
    v_add_f32 v43, v43, v75
    v_add_f32 v44, v44, v76
    v_add_f32 v45, v45, v77
    v_add_f32 v46, v46, v78
    v_add_f32 v47, v47, v79
    v_add_f32 v48, v48, v80
    v_add_f32 v49, v49, v81
    v_add_f32 v50, v50, v82
    v_add_f32 v51, v51, v83
    v_add_f32 v52, v52, v84
    v_add_f32 v53, v53, v85
    v_add_f32 v54, v54, v86
    v_add_f32 v55, v55, v87
    v_add_f32 v56, v56, v88
    v_add_f32 v57, v57, v89
    v_add_f32 v58, v58, v90
    v_add_f32 v59, v59, v91
    v_add_f32 v60, v60, v92
    v_add_f32 v61, v61, v93
    v_add_f32 v62, v62, v94
    v_add_f32 v63, v63, v95
    v_add_f32 v32, v32, v48
    v_add_f32 v33, v33, v49
    v_add_f32 v34, v34, v50
    v_add_f32 v35, v35, v51
    v_add_f32 v36, v36, v52
    v_add_f32 v37, v37, v53
    v_add_f32 v38, v38, v54
    v_add_f32 v39, v39, v55
    v_add_f32 v40, v40, v56
    v_add_f32 v41, v41, v57
    v_add_f32 v42, v42, v58
    v_add_f32 v43, v43, v59
    v_add_f32 v44, v44, v60
    v_add_f32 v45, v45, v61
    v_add_f32 v46, v46, v62
    v_add_f32 v47, v47, v63
    v_add_f32 v32, v32, v40
    v_add_f32 v33, v33, v41
    v_add_f32 v34, v34, v42
    v_add_f32 v35, v35, v43
    v_add_f32 v36, v36, v44
    v_add_f32 v37, v37, v45
    v_add_f32 v38, v38, v46
    v_add_f32 v39, v39, v47
    v_mul_f32 v6, v6, v104
    v_mul_f32 v32, v32, v6
    v_mul_f32 v33, v33, v6
    v_mul_f32 v34, v34, v6
    v_mul_f32 v35, v35, v6
    v_mul_f32 v36, v36, v6
    v_mul_f32 v37, v37, v6
    v_mul_f32 v38, v38, v6
    v_mul_f32 v39, v39, v6
    buffer_store_dwordx4 v[32:35], v1, s[76:79], s91 offen sc1
    buffer_store_dwordx4 v[36:39], v1, s[76:79], s91 offen offset:1024 sc1
    s_mov_b64 exec, 1
    buffer_store_dword v7, off, s[76:79], s96 sc1
    v_mov_b32 v6, 1
    s_lshl_b32 s89, s82, 6
    s_waitcnt vmcnt(0)
    buffer_atomic_add v6, off, s[72:75], s89 sc0
    s_waitcnt vmcnt(0)
    ds_write_b32 v30, v6 offset:12356
    s_mov_b64 exec, -1
    s_waitcnt lgkmcnt(0)
L_wait_ticket:
    s_barrier
    ds_read_b32 v6, v30 offset:12356
    s_waitcnt lgkmcnt(0)
    v_readfirstlane_b32 s89, v6
    s_cmp_lg_u32 s89, 63
    s_cbranch_scc1 L_exit
    s_lshl_b32 s89, s82, 8
    s_add_u32 s89, s89, 0x80000
    v_lshlrev_b32 v6, 2, v0
    buffer_load_dword v7, v6, s[76:79], s89 offen sc1
    s_lshl_b32 s84, s82, 17
    s_lshl_b32 s89, s80, 14
    s_add_u32 s84, s84, s89
    s_add_u32 s85, s84, 4096
    s_add_u32 s86, s84, 8192
    s_add_u32 s87, s84, 12288
    buffer_load_dwordx4 v[32:35], v1, s[76:79], s84 offen offset:0 sc1
    buffer_load_dwordx4 v[36:39], v1, s[76:79], s84 offen offset:1024 sc1
    buffer_load_dwordx4 v[40:43], v1, s[76:79], s84 offen offset:2048 sc1
    buffer_load_dwordx4 v[44:47], v1, s[76:79], s84 offen offset:3072 sc1
    buffer_load_dwordx4 v[48:51], v1, s[76:79], s85 offen offset:0 sc1
    buffer_load_dwordx4 v[52:55], v1, s[76:79], s85 offen offset:1024 sc1
    buffer_load_dwordx4 v[56:59], v1, s[76:79], s85 offen offset:2048 sc1
    buffer_load_dwordx4 v[60:63], v1, s[76:79], s85 offen offset:3072 sc1
    buffer_load_dwordx4 v[64:67], v1, s[76:79], s86 offen offset:0 sc1
    buffer_load_dwordx4 v[68:71], v1, s[76:79], s86 offen offset:1024 sc1
    buffer_load_dwordx4 v[72:75], v1, s[76:79], s86 offen offset:2048 sc1
    buffer_load_dwordx4 v[76:79], v1, s[76:79], s86 offen offset:3072 sc1
    buffer_load_dwordx4 v[80:83], v1, s[76:79], s87 offen offset:0 sc1
    buffer_load_dwordx4 v[84:87], v1, s[76:79], s87 offen offset:1024 sc1
    buffer_load_dwordx4 v[88:91], v1, s[76:79], s87 offen offset:2048 sc1
    buffer_load_dwordx4 v[92:95], v1, s[76:79], s87 offen offset:3072 sc1
    s_lshl_b32 s89, s82, 11
    s_add_u32 s89, s89, 0xE0000
    buffer_load_dwordx4 v[96:99], v1, s[76:79], s89 offen sc1
    buffer_load_dwordx4 v[100:103], v1, s[76:79], s89 offen offset:1024 sc1
    s_lshl_b32 s89, s80, 3
    s_waitcnt vmcnt(18)
    v_sub_f32_dpp v6, v7, v7 quad_perm:[1,0,3,2] row_mask:0xf bank_mask:0xf
    v_exp_f32 v6, v6
    s_nop 0
    v_add_f32 v6, 1.0, v6
    v_rcp_f32 v6, v6
    s_nop 1
    v_readlane_b32 s91, v6, s89
    s_add_u32 s89, s89, 1
    s_waitcnt vmcnt(16)
    s_nop 0
    v_mul_f32 v8, s91, v32
    v_mul_f32 v9, s91, v33
    v_mul_f32 v10, s91, v34
    v_mul_f32 v11, s91, v35
    v_mul_f32 v12, s91, v36
    v_mul_f32 v13, s91, v37
    v_mul_f32 v14, s91, v38
    v_mul_f32 v15, s91, v39
    v_readlane_b32 s91, v6, s89
    s_add_u32 s89, s89, 1
    s_waitcnt vmcnt(14)
    s_nop 0
    v_fmac_f32 v8, s91, v40
    v_fmac_f32 v9, s91, v41
    v_fmac_f32 v10, s91, v42
    v_fmac_f32 v11, s91, v43
    v_fmac_f32 v12, s91, v44
    v_fmac_f32 v13, s91, v45
    v_fmac_f32 v14, s91, v46
    v_fmac_f32 v15, s91, v47
    v_readlane_b32 s91, v6, s89
    s_add_u32 s89, s89, 1
    s_waitcnt vmcnt(12)
    s_nop 0
    v_fmac_f32 v8, s91, v48
    v_fmac_f32 v9, s91, v49
    v_fmac_f32 v10, s91, v50
    v_fmac_f32 v11, s91, v51
    v_fmac_f32 v12, s91, v52
    v_fmac_f32 v13, s91, v53
    v_fmac_f32 v14, s91, v54
    v_fmac_f32 v15, s91, v55
    v_readlane_b32 s91, v6, s89
    s_add_u32 s89, s89, 1
    s_waitcnt vmcnt(10)
    s_nop 0
    v_fmac_f32 v8, s91, v56
    v_fmac_f32 v9, s91, v57
    v_fmac_f32 v10, s91, v58
    v_fmac_f32 v11, s91, v59
    v_fmac_f32 v12, s91, v60
    v_fmac_f32 v13, s91, v61
    v_fmac_f32 v14, s91, v62
    v_fmac_f32 v15, s91, v63
    v_readlane_b32 s91, v6, s89
    s_add_u32 s89, s89, 1
    s_waitcnt vmcnt(8)
    s_nop 0
    v_fmac_f32 v8, s91, v64
    v_fmac_f32 v9, s91, v65
    v_fmac_f32 v10, s91, v66
    v_fmac_f32 v11, s91, v67
    v_fmac_f32 v12, s91, v68
    v_fmac_f32 v13, s91, v69
    v_fmac_f32 v14, s91, v70
    v_fmac_f32 v15, s91, v71
    v_readlane_b32 s91, v6, s89
    s_add_u32 s89, s89, 1
    s_waitcnt vmcnt(6)
    s_nop 0
    v_fmac_f32 v8, s91, v72
    v_fmac_f32 v9, s91, v73
    v_fmac_f32 v10, s91, v74
    v_fmac_f32 v11, s91, v75
    v_fmac_f32 v12, s91, v76
    v_fmac_f32 v13, s91, v77
    v_fmac_f32 v14, s91, v78
    v_fmac_f32 v15, s91, v79
    v_readlane_b32 s91, v6, s89
    s_add_u32 s89, s89, 1
    s_waitcnt vmcnt(4)
    s_nop 0
    v_fmac_f32 v8, s91, v80
    v_fmac_f32 v9, s91, v81
    v_fmac_f32 v10, s91, v82
    v_fmac_f32 v11, s91, v83
    v_fmac_f32 v12, s91, v84
    v_fmac_f32 v13, s91, v85
    v_fmac_f32 v14, s91, v86
    v_fmac_f32 v15, s91, v87
    v_readlane_b32 s91, v6, s89
    s_add_u32 s89, s89, 1
    s_waitcnt vmcnt(2)
    s_nop 0
    v_fmac_f32 v8, s91, v88
    v_fmac_f32 v9, s91, v89
    v_fmac_f32 v10, s91, v90
    v_fmac_f32 v11, s91, v91
    v_fmac_f32 v12, s91, v92
    v_fmac_f32 v13, s91, v93
    v_fmac_f32 v14, s91, v94
    v_fmac_f32 v15, s91, v95
    ds_write_b128 v28, v[8:11] offset:12416
    ds_write_b128 v28, v[12:15] offset:13440
    s_waitcnt lgkmcnt(0)
    s_barrier
    s_cmp_lg_u32 s80, 0
    s_cbranch_scc1 L_exit
    ds_read_b128 v[32:35], v1 offset:12416
    ds_read_b128 v[36:39], v1 offset:13440
    ds_read_b128 v[40:43], v1 offset:14464
    ds_read_b128 v[44:47], v1 offset:15488
    ds_read_b128 v[48:51], v1 offset:16512
    ds_read_b128 v[52:55], v1 offset:17536
    ds_read_b128 v[56:59], v1 offset:18560
    ds_read_b128 v[60:63], v1 offset:19584
    ds_read_b128 v[64:67], v1 offset:20608
    ds_read_b128 v[68:71], v1 offset:21632
    ds_read_b128 v[72:75], v1 offset:22656
    ds_read_b128 v[76:79], v1 offset:23680
    ds_read_b128 v[80:83], v1 offset:24704
    ds_read_b128 v[84:87], v1 offset:25728
    s_waitcnt lgkmcnt(8)
    ds_read_b128 v[88:91], v1 offset:26752
    ds_read_b128 v[92:95], v1 offset:27776
    s_lshl_b32 s89, s82, 10
    s_waitcnt vmcnt(0) lgkmcnt(0)
    v_add_f32 v32, v32, v64
    v_add_f32 v33, v33, v65
    v_add_f32 v34, v34, v66
    v_add_f32 v35, v35, v67
    v_add_f32 v36, v36, v68
    v_add_f32 v37, v37, v69
    v_add_f32 v38, v38, v70
    v_add_f32 v39, v39, v71
    v_add_f32 v40, v40, v72
    v_add_f32 v41, v41, v73
    v_add_f32 v42, v42, v74
    v_add_f32 v43, v43, v75
    v_add_f32 v44, v44, v76
    v_add_f32 v45, v45, v77
    v_add_f32 v46, v46, v78
    v_add_f32 v47, v47, v79
    v_add_f32 v48, v48, v80
    v_add_f32 v49, v49, v81
    v_add_f32 v50, v50, v82
    v_add_f32 v51, v51, v83
    v_add_f32 v52, v52, v84
    v_add_f32 v53, v53, v85
    v_add_f32 v54, v54, v86
    v_add_f32 v55, v55, v87
    v_add_f32 v56, v56, v88
    v_add_f32 v57, v57, v89
    v_add_f32 v58, v58, v90
    v_add_f32 v59, v59, v91
    v_add_f32 v60, v60, v92
    v_add_f32 v61, v61, v93
    v_add_f32 v62, v62, v94
    v_add_f32 v63, v63, v95
    v_add_f32 v32, v32, v48
    v_add_f32 v33, v33, v49
    v_add_f32 v34, v34, v50
    v_add_f32 v35, v35, v51
    v_add_f32 v36, v36, v52
    v_add_f32 v37, v37, v53
    v_add_f32 v38, v38, v54
    v_add_f32 v39, v39, v55
    v_add_f32 v40, v40, v56
    v_add_f32 v41, v41, v57
    v_add_f32 v42, v42, v58
    v_add_f32 v43, v43, v59
    v_add_f32 v44, v44, v60
    v_add_f32 v45, v45, v61
    v_add_f32 v46, v46, v62
    v_add_f32 v47, v47, v63
    v_add_f32 v32, v32, v40
    v_add_f32 v33, v33, v41
    v_add_f32 v34, v34, v42
    v_add_f32 v35, v35, v43
    v_add_f32 v36, v36, v44
    v_add_f32 v37, v37, v45
    v_add_f32 v38, v38, v46
    v_add_f32 v39, v39, v47
    v_add_f32 v32, v32, v96
    v_add_f32 v33, v33, v97
    v_add_f32 v34, v34, v98
    v_add_f32 v35, v35, v99
    v_add_f32 v36, v36, v100
    v_add_f32 v37, v37, v101
    v_add_f32 v38, v38, v102
    v_add_f32 v39, v39, v103
    v_cvt_pk_bf16_f32 v8, v32, v33
    v_cvt_pk_bf16_f32 v9, v34, v35
    v_cvt_pk_bf16_f32 v10, v36, v37
    v_cvt_pk_bf16_f32 v11, v38, v39
    buffer_store_dwordx4 v[8:11], v1, s[68:71], s89 offen
L_exit:
    s_endpgm
L_ffn:
    s_setprio 3
    v_lshrrev_b32 v6, 3, v0
    v_and_b32 v7, 7, v0
    s_mov_b32 s89, 229376
    v_mul_lo_u32 v4, v6, s89
    v_lshl_add_u32 v4, v7, 4, v4
    v_lshlrev_b32 v5, 7, v6
    s_lshl_b32 s89, s81, 7
    s_lshl_b32 s91, s82, 10
    s_waitcnt lgkmcnt(0)
    s_mov_b32 s48, s4
    s_mov_b32 s49, s5
    s_mov_b32 s50, 0x1000
    s_mov_b32 s51, 0x00020000
    s_mov_b32 s52, s16
    s_mov_b32 s53, s17
    s_mov_b32 s54, 0x1c0000
    s_mov_b32 s55, 0x00020000
    s_mov_b32 s56, s18
    s_mov_b32 s57, s19
    s_mov_b32 s58, 0x1c0000
    s_mov_b32 s59, 0x00020000
    s_mov_b32 s60, s20
    s_mov_b32 s61, s21
    s_mov_b32 s62, 0x1c0000
    s_mov_b32 s63, 0x00020000
    s_mov_b32 s64, s22
    s_mov_b32 s65, s23
    s_mov_b32 s66, 0x400
    s_mov_b32 s67, 0x00020000
    s_mov_b32 s72, s26
    s_mov_b32 s73, s27
    s_mov_b32 s74, 0x100
    s_mov_b32 s75, 0x00020000
    s_mov_b32 s76, s28
    s_mov_b32 s77, s29
    s_mov_b32 s78, 0x100000
    s_mov_b32 s79, 0x00020000
    s_lshl_b32 s96, s82, 6
    s_lshr_b32 s88, s81, 4
    s_lshl_b32 s88, s88, 2
    s_add_u32 s96, s96, s88
    s_add_u32 s96, s96, 4
    s_and_b32 s88, s81, 15
    s_lshl_b32 s88, s88, 1
    s_lshl_b32 s90, 1, s88
    s_mov_b64 exec, 1
    v_mov_b32 v2, s90
    buffer_atomic_or v2, off, s[72:75], s96 sc0
    s_waitcnt vmcnt(0)
    v_readfirstlane_b32 s94, v2
    s_lshr_b32 s94, s94, s88
    s_bitcmp1_b32 s94, 0
    s_cbranch_scc1 L_hs_poll
    v_mov_b32 v2, 16
    buffer_atomic_swap v2, off, s[76:79], s3 sc0
    s_lshl_b32 s90, s90, 1
    s_waitcnt vmcnt(0)
    v_mov_b32 v2, s90
    buffer_atomic_or v2, off, s[72:75], s96
    s_branch L_hs_done
L_hs_poll:
    s_bitcmp1_b32 s94, 1
    s_cbranch_scc1 L_hs_done
    v_mov_b32 v2, s90
    buffer_atomic_or v2, off, s[72:75], s96 sc0
    s_waitcnt vmcnt(0)
    v_readfirstlane_b32 s94, v2
    s_lshr_b32 s94, s94, s88
    s_branch L_hs_poll
L_hs_done:
    s_mov_b64 exec, -1
    s_waitcnt vmcnt(0)
    s_lshl_b32 s98, s82, 1
    buffer_load_dwordx4 v[160:163], v1, s[48:51], s91 offen
    buffer_load_dwordx4 v[164:167], v1, s[64:67], 0 offen
    s_barrier
    s_waitcnt vmcnt(0)
    v_dot2_f32_bf16 v6, v160, v164, 0
    v_dot2_f32_bf16 v6, v161, v165, v6
    v_dot2_f32_bf16 v6, v162, v166, v6
    v_dot2_f32_bf16 v6, v163, v167, v6
    s_nop 1
    s_nop 1
    v_add_f32_dpp v6, v6, v6 row_mirror row_mask:0xf bank_mask:0xf
    s_nop 1
    v_add_f32_dpp v6, v6, v6 row_half_mirror row_mask:0xf bank_mask:0xf
    s_nop 1
    v_add_f32_dpp v6, v6, v6 quad_perm:[3,2,1,0] row_mask:0xf bank_mask:0xf
    s_nop 1
    v_add_f32_dpp v6, v6, v6 quad_perm:[1,0,3,2] row_mask:0xf bank_mask:0xf
    v_mov_b32 v7, v6
    s_nop 1
    v_permlane32_swap_b32 v6, v7
    v_add_f32 v6, v6, v7
    v_mov_b32 v7, v6
    s_nop 1
    v_permlane16_swap_b32 v6, v7
    v_add_f32 v6, v6, v7
    v_mul_f32 v6, 0xbfb8aa3b, v6
    v_exp_f32 v6, v6
    s_nop 0
    v_add_f32 v6, 1.0, v6
    v_rcp_f32 v6, v6
    v_mov_b32 v7, 0
    ds_write_b32 v7, v6 offset:12352
    v_sub_f32 v6, 1.0, v6
    s_lshl_b32 s88, s83, 5
    s_add_u32 s88, s88, s81
    s_cmp_ge_u32 s88, 28
    s_cbranch_scc1 L_ffn_fin
    s_lshl_b32 s91, s82, 6
    s_add_u32 s91, s91, s98
    s_lshl_b32 s91, s91, 4
    s_mul_i32 s89, s98, 224
    s_add_u32 s89, s89, s81
    s_lshl_b32 s89, s89, 7
    s_add_u32 s98, s98, 1
    s_and_b32 s98, s98, 7
    buffer_load_dwordx4 v[24:27], v5, s[48:51], s91 offen
    s_add_u32 s91, s91, 16
    buffer_load_dwordx4 v[32:35], v4, s[52:55], s89 offen
    buffer_load_dwordx4 v[64:67], v4, s[56:59], s89 offen
    buffer_load_dwordx4 v[36:39], v4, s[52:55], s89 offen offset:3584
    buffer_load_dwordx4 v[68:71], v4, s[56:59], s89 offen offset:3584
    s_add_u32 s89, s89, 7168
    buffer_load_dwordx4 v[40:43], v4, s[52:55], s89 offen
    buffer_load_dwordx4 v[72:75], v4, s[56:59], s89 offen
    buffer_load_dwordx4 v[44:47], v4, s[52:55], s89 offen offset:3584
    buffer_load_dwordx4 v[76:79], v4, s[56:59], s89 offen offset:3584
    s_add_u32 s89, s89, 7168
    buffer_load_dwordx4 v[48:51], v4, s[52:55], s89 offen
    buffer_load_dwordx4 v[80:83], v4, s[56:59], s89 offen
    buffer_load_dwordx4 v[52:55], v4, s[52:55], s89 offen offset:3584
    buffer_load_dwordx4 v[84:87], v4, s[56:59], s89 offen offset:3584
    s_add_u32 s89, s89, 7168
    buffer_load_dwordx4 v[56:59], v4, s[52:55], s89 offen
    buffer_load_dwordx4 v[88:91], v4, s[56:59], s89 offen
    buffer_load_dwordx4 v[60:63], v4, s[52:55], s89 offen offset:3584
    buffer_load_dwordx4 v[92:95], v4, s[56:59], s89 offen offset:3584
    s_add_u32 s89, s89, 7168
    s_lshl_b32 s91, s82, 6
    s_add_u32 s91, s91, s98
    s_lshl_b32 s91, s91, 4
    s_mul_i32 s89, s98, 224
    s_add_u32 s89, s89, s81
    s_lshl_b32 s89, s89, 7
    s_add_u32 s98, s98, 1
    s_and_b32 s98, s98, 7
    buffer_load_dwordx4 v[28:31], v5, s[48:51], s91 offen
    s_add_u32 s91, s91, 16
    buffer_load_dwordx4 v[96:99], v4, s[52:55], s89 offen
    buffer_load_dwordx4 v[128:131], v4, s[56:59], s89 offen
    buffer_load_dwordx4 v[100:103], v4, s[52:55], s89 offen offset:3584
    buffer_load_dwordx4 v[132:135], v4, s[56:59], s89 offen offset:3584
    s_add_u32 s89, s89, 7168
    buffer_load_dwordx4 v[104:107], v4, s[52:55], s89 offen
    buffer_load_dwordx4 v[136:139], v4, s[56:59], s89 offen
    buffer_load_dwordx4 v[108:111], v4, s[52:55], s89 offen offset:3584
    buffer_load_dwordx4 v[140:143], v4, s[56:59], s89 offen offset:3584
    s_add_u32 s89, s89, 7168
    buffer_load_dwordx4 v[112:115], v4, s[52:55], s89 offen
    buffer_load_dwordx4 v[144:147], v4, s[56:59], s89 offen
    buffer_load_dwordx4 v[116:119], v4, s[52:55], s89 offen offset:3584
    buffer_load_dwordx4 v[148:151], v4, s[56:59], s89 offen offset:3584
    s_add_u32 s89, s89, 7168
    buffer_load_dwordx4 v[120:123], v4, s[52:55], s89 offen
    buffer_load_dwordx4 v[152:155], v4, s[56:59], s89 offen
    buffer_load_dwordx4 v[124:127], v4, s[52:55], s89 offen offset:3584
    buffer_load_dwordx4 v[156:159], v4, s[56:59], s89 offen offset:3584
    s_add_u32 s89, s89, 7168
    v_mov_b32 v8, 0
    v_mov_b32 v9, 0
    v_mov_b32 v10, 0
    v_mov_b32 v11, 0
    v_mov_b32 v12, 0
    v_mov_b32 v13, 0
    v_mov_b32 v14, 0
    v_mov_b32 v15, 0
    v_mov_b32 v16, 0
    v_mov_b32 v17, 0
    v_mov_b32 v18, 0
    v_mov_b32 v19, 0
    v_mov_b32 v20, 0
    v_mov_b32 v21, 0
    v_mov_b32 v22, 0
    v_mov_b32 v23, 0
    s_mov_b32 s88, 0
L_ffn_loop:
    s_waitcnt vmcnt(17)
    v_and_b32 v2, 0xffff, v24
    v_lshlrev_b32 v3, 16, v24
    v_dot2c_f32_bf16 v8, v2, v32
    v_dot2c_f32_bf16 v9, v3, v32
    v_dot2c_f32_bf16 v16, v2, v64
    v_dot2c_f32_bf16 v17, v3, v64
    v_dot2c_f32_bf16 v10, v2, v33
    v_dot2c_f32_bf16 v11, v3, v33
    v_dot2c_f32_bf16 v18, v2, v65
    v_dot2c_f32_bf16 v19, v3, v65
    v_dot2c_f32_bf16 v12, v2, v34
    v_dot2c_f32_bf16 v13, v3, v34
    v_dot2c_f32_bf16 v20, v2, v66
    v_dot2c_f32_bf16 v21, v3, v66
    v_dot2c_f32_bf16 v14, v2, v35
    v_dot2c_f32_bf16 v15, v3, v35
    v_dot2c_f32_bf16 v22, v2, v67
    v_dot2c_f32_bf16 v23, v3, v67
    v_lshrrev_b32 v2, 16, v24
    v_and_b32 v3, 0xffff0000, v24
    v_dot2c_f32_bf16 v8, v2, v36
    v_dot2c_f32_bf16 v9, v3, v36
    v_dot2c_f32_bf16 v16, v2, v68
    v_dot2c_f32_bf16 v17, v3, v68
    v_dot2c_f32_bf16 v10, v2, v37
    v_dot2c_f32_bf16 v11, v3, v37
    v_dot2c_f32_bf16 v18, v2, v69
    v_dot2c_f32_bf16 v19, v3, v69
    v_dot2c_f32_bf16 v12, v2, v38
    v_dot2c_f32_bf16 v13, v3, v38
    v_dot2c_f32_bf16 v20, v2, v70
    v_dot2c_f32_bf16 v21, v3, v70
    v_dot2c_f32_bf16 v14, v2, v39
    v_dot2c_f32_bf16 v15, v3, v39
    v_dot2c_f32_bf16 v22, v2, v71
    v_dot2c_f32_bf16 v23, v3, v71
    v_and_b32 v2, 0xffff, v25
    v_lshlrev_b32 v3, 16, v25
    v_dot2c_f32_bf16 v8, v2, v40
    v_dot2c_f32_bf16 v9, v3, v40
    v_dot2c_f32_bf16 v16, v2, v72
    v_dot2c_f32_bf16 v17, v3, v72
    v_dot2c_f32_bf16 v10, v2, v41
    v_dot2c_f32_bf16 v11, v3, v41
    v_dot2c_f32_bf16 v18, v2, v73
    v_dot2c_f32_bf16 v19, v3, v73
    v_dot2c_f32_bf16 v12, v2, v42
    v_dot2c_f32_bf16 v13, v3, v42
    v_dot2c_f32_bf16 v20, v2, v74
    v_dot2c_f32_bf16 v21, v3, v74
    v_dot2c_f32_bf16 v14, v2, v43
    v_dot2c_f32_bf16 v15, v3, v43
    v_dot2c_f32_bf16 v22, v2, v75
    v_dot2c_f32_bf16 v23, v3, v75
    v_lshrrev_b32 v2, 16, v25
    v_and_b32 v3, 0xffff0000, v25
    v_dot2c_f32_bf16 v8, v2, v44
    v_dot2c_f32_bf16 v9, v3, v44
    v_dot2c_f32_bf16 v16, v2, v76
    v_dot2c_f32_bf16 v17, v3, v76
    v_dot2c_f32_bf16 v10, v2, v45
    v_dot2c_f32_bf16 v11, v3, v45
    v_dot2c_f32_bf16 v18, v2, v77
    v_dot2c_f32_bf16 v19, v3, v77
    v_dot2c_f32_bf16 v12, v2, v46
    v_dot2c_f32_bf16 v13, v3, v46
    v_dot2c_f32_bf16 v20, v2, v78
    v_dot2c_f32_bf16 v21, v3, v78
    v_dot2c_f32_bf16 v14, v2, v47
    v_dot2c_f32_bf16 v15, v3, v47
    v_dot2c_f32_bf16 v22, v2, v79
    v_dot2c_f32_bf16 v23, v3, v79
    v_and_b32 v2, 0xffff, v26
    v_lshlrev_b32 v3, 16, v26
    v_dot2c_f32_bf16 v8, v2, v48
    v_dot2c_f32_bf16 v9, v3, v48
    v_dot2c_f32_bf16 v16, v2, v80
    v_dot2c_f32_bf16 v17, v3, v80
    v_dot2c_f32_bf16 v10, v2, v49
    v_dot2c_f32_bf16 v11, v3, v49
    v_dot2c_f32_bf16 v18, v2, v81
    v_dot2c_f32_bf16 v19, v3, v81
    v_dot2c_f32_bf16 v12, v2, v50
    v_dot2c_f32_bf16 v13, v3, v50
    v_dot2c_f32_bf16 v20, v2, v82
    v_dot2c_f32_bf16 v21, v3, v82
    v_dot2c_f32_bf16 v14, v2, v51
    v_dot2c_f32_bf16 v15, v3, v51
    v_dot2c_f32_bf16 v22, v2, v83
    v_dot2c_f32_bf16 v23, v3, v83
    v_lshrrev_b32 v2, 16, v26
    v_and_b32 v3, 0xffff0000, v26
    v_dot2c_f32_bf16 v8, v2, v52
    v_dot2c_f32_bf16 v9, v3, v52
    v_dot2c_f32_bf16 v16, v2, v84
    v_dot2c_f32_bf16 v17, v3, v84
    v_dot2c_f32_bf16 v10, v2, v53
    v_dot2c_f32_bf16 v11, v3, v53
    v_dot2c_f32_bf16 v18, v2, v85
    v_dot2c_f32_bf16 v19, v3, v85
    v_dot2c_f32_bf16 v12, v2, v54
    v_dot2c_f32_bf16 v13, v3, v54
    v_dot2c_f32_bf16 v20, v2, v86
    v_dot2c_f32_bf16 v21, v3, v86
    v_dot2c_f32_bf16 v14, v2, v55
    v_dot2c_f32_bf16 v15, v3, v55
    v_dot2c_f32_bf16 v22, v2, v87
    v_dot2c_f32_bf16 v23, v3, v87
    v_and_b32 v2, 0xffff, v27
    v_lshlrev_b32 v3, 16, v27
    v_dot2c_f32_bf16 v8, v2, v56
    v_dot2c_f32_bf16 v9, v3, v56
    v_dot2c_f32_bf16 v16, v2, v88
    v_dot2c_f32_bf16 v17, v3, v88
    v_dot2c_f32_bf16 v10, v2, v57
    v_dot2c_f32_bf16 v11, v3, v57
    v_dot2c_f32_bf16 v18, v2, v89
    v_dot2c_f32_bf16 v19, v3, v89
    v_dot2c_f32_bf16 v12, v2, v58
    v_dot2c_f32_bf16 v13, v3, v58
    v_dot2c_f32_bf16 v20, v2, v90
    v_dot2c_f32_bf16 v21, v3, v90
    v_dot2c_f32_bf16 v14, v2, v59
    v_dot2c_f32_bf16 v15, v3, v59
    v_dot2c_f32_bf16 v22, v2, v91
    v_dot2c_f32_bf16 v23, v3, v91
    v_lshrrev_b32 v2, 16, v27
    v_and_b32 v3, 0xffff0000, v27
    v_dot2c_f32_bf16 v8, v2, v60
    v_dot2c_f32_bf16 v9, v3, v60
    v_dot2c_f32_bf16 v16, v2, v92
    v_dot2c_f32_bf16 v17, v3, v92
    v_dot2c_f32_bf16 v10, v2, v61
    v_dot2c_f32_bf16 v11, v3, v61
    v_dot2c_f32_bf16 v18, v2, v93
    v_dot2c_f32_bf16 v19, v3, v93
    v_dot2c_f32_bf16 v12, v2, v62
    v_dot2c_f32_bf16 v13, v3, v62
    v_dot2c_f32_bf16 v20, v2, v94
    v_dot2c_f32_bf16 v21, v3, v94
    v_dot2c_f32_bf16 v14, v2, v63
    v_dot2c_f32_bf16 v15, v3, v63
    v_dot2c_f32_bf16 v22, v2, v95
    v_dot2c_f32_bf16 v23, v3, v95
    s_lshl_b32 s91, s82, 6
    s_add_u32 s91, s91, s98
    s_lshl_b32 s91, s91, 4
    s_mul_i32 s89, s98, 224
    s_add_u32 s89, s89, s81
    s_lshl_b32 s89, s89, 7
    s_add_u32 s98, s98, 1
    s_and_b32 s98, s98, 7
    buffer_load_dwordx4 v[24:27], v5, s[48:51], s91 offen
    s_add_u32 s91, s91, 16
    buffer_load_dwordx4 v[32:35], v4, s[52:55], s89 offen
    buffer_load_dwordx4 v[64:67], v4, s[56:59], s89 offen
    buffer_load_dwordx4 v[36:39], v4, s[52:55], s89 offen offset:3584
    buffer_load_dwordx4 v[68:71], v4, s[56:59], s89 offen offset:3584
    s_add_u32 s89, s89, 7168
    buffer_load_dwordx4 v[40:43], v4, s[52:55], s89 offen
    buffer_load_dwordx4 v[72:75], v4, s[56:59], s89 offen
    buffer_load_dwordx4 v[44:47], v4, s[52:55], s89 offen offset:3584
    buffer_load_dwordx4 v[76:79], v4, s[56:59], s89 offen offset:3584
    s_add_u32 s89, s89, 7168
    buffer_load_dwordx4 v[48:51], v4, s[52:55], s89 offen
    buffer_load_dwordx4 v[80:83], v4, s[56:59], s89 offen
    buffer_load_dwordx4 v[52:55], v4, s[52:55], s89 offen offset:3584
    buffer_load_dwordx4 v[84:87], v4, s[56:59], s89 offen offset:3584
    s_add_u32 s89, s89, 7168
    buffer_load_dwordx4 v[56:59], v4, s[52:55], s89 offen
    buffer_load_dwordx4 v[88:91], v4, s[56:59], s89 offen
    buffer_load_dwordx4 v[60:63], v4, s[52:55], s89 offen offset:3584
    buffer_load_dwordx4 v[92:95], v4, s[56:59], s89 offen offset:3584
    s_add_u32 s89, s89, 7168
    s_waitcnt vmcnt(17)
    v_and_b32 v2, 0xffff, v28
    v_lshlrev_b32 v3, 16, v28
    v_dot2c_f32_bf16 v8, v2, v96
    v_dot2c_f32_bf16 v9, v3, v96
    v_dot2c_f32_bf16 v16, v2, v128
    v_dot2c_f32_bf16 v17, v3, v128
    v_dot2c_f32_bf16 v10, v2, v97
    v_dot2c_f32_bf16 v11, v3, v97
    v_dot2c_f32_bf16 v18, v2, v129
    v_dot2c_f32_bf16 v19, v3, v129
    v_dot2c_f32_bf16 v12, v2, v98
    v_dot2c_f32_bf16 v13, v3, v98
    v_dot2c_f32_bf16 v20, v2, v130
    v_dot2c_f32_bf16 v21, v3, v130
    v_dot2c_f32_bf16 v14, v2, v99
    v_dot2c_f32_bf16 v15, v3, v99
    v_dot2c_f32_bf16 v22, v2, v131
    v_dot2c_f32_bf16 v23, v3, v131
    v_lshrrev_b32 v2, 16, v28
    v_and_b32 v3, 0xffff0000, v28
    v_dot2c_f32_bf16 v8, v2, v100
    v_dot2c_f32_bf16 v9, v3, v100
    v_dot2c_f32_bf16 v16, v2, v132
    v_dot2c_f32_bf16 v17, v3, v132
    v_dot2c_f32_bf16 v10, v2, v101
    v_dot2c_f32_bf16 v11, v3, v101
    v_dot2c_f32_bf16 v18, v2, v133
    v_dot2c_f32_bf16 v19, v3, v133
    v_dot2c_f32_bf16 v12, v2, v102
    v_dot2c_f32_bf16 v13, v3, v102
    v_dot2c_f32_bf16 v20, v2, v134
    v_dot2c_f32_bf16 v21, v3, v134
    v_dot2c_f32_bf16 v14, v2, v103
    v_dot2c_f32_bf16 v15, v3, v103
    v_dot2c_f32_bf16 v22, v2, v135
    v_dot2c_f32_bf16 v23, v3, v135
    v_and_b32 v2, 0xffff, v29
    v_lshlrev_b32 v3, 16, v29
    v_dot2c_f32_bf16 v8, v2, v104
    v_dot2c_f32_bf16 v9, v3, v104
    v_dot2c_f32_bf16 v16, v2, v136
    v_dot2c_f32_bf16 v17, v3, v136
    v_dot2c_f32_bf16 v10, v2, v105
    v_dot2c_f32_bf16 v11, v3, v105
    v_dot2c_f32_bf16 v18, v2, v137
    v_dot2c_f32_bf16 v19, v3, v137
    v_dot2c_f32_bf16 v12, v2, v106
    v_dot2c_f32_bf16 v13, v3, v106
    v_dot2c_f32_bf16 v20, v2, v138
    v_dot2c_f32_bf16 v21, v3, v138
    v_dot2c_f32_bf16 v14, v2, v107
    v_dot2c_f32_bf16 v15, v3, v107
    v_dot2c_f32_bf16 v22, v2, v139
    v_dot2c_f32_bf16 v23, v3, v139
    v_lshrrev_b32 v2, 16, v29
    v_and_b32 v3, 0xffff0000, v29
    v_dot2c_f32_bf16 v8, v2, v108
    v_dot2c_f32_bf16 v9, v3, v108
    v_dot2c_f32_bf16 v16, v2, v140
    v_dot2c_f32_bf16 v17, v3, v140
    v_dot2c_f32_bf16 v10, v2, v109
    v_dot2c_f32_bf16 v11, v3, v109
    v_dot2c_f32_bf16 v18, v2, v141
    v_dot2c_f32_bf16 v19, v3, v141
    v_dot2c_f32_bf16 v12, v2, v110
    v_dot2c_f32_bf16 v13, v3, v110
    v_dot2c_f32_bf16 v20, v2, v142
    v_dot2c_f32_bf16 v21, v3, v142
    v_dot2c_f32_bf16 v14, v2, v111
    v_dot2c_f32_bf16 v15, v3, v111
    v_dot2c_f32_bf16 v22, v2, v143
    v_dot2c_f32_bf16 v23, v3, v143
    v_and_b32 v2, 0xffff, v30
    v_lshlrev_b32 v3, 16, v30
    v_dot2c_f32_bf16 v8, v2, v112
    v_dot2c_f32_bf16 v9, v3, v112
    v_dot2c_f32_bf16 v16, v2, v144
    v_dot2c_f32_bf16 v17, v3, v144
    v_dot2c_f32_bf16 v10, v2, v113
    v_dot2c_f32_bf16 v11, v3, v113
    v_dot2c_f32_bf16 v18, v2, v145
    v_dot2c_f32_bf16 v19, v3, v145
    v_dot2c_f32_bf16 v12, v2, v114
    v_dot2c_f32_bf16 v13, v3, v114
    v_dot2c_f32_bf16 v20, v2, v146
    v_dot2c_f32_bf16 v21, v3, v146
    v_dot2c_f32_bf16 v14, v2, v115
    v_dot2c_f32_bf16 v15, v3, v115
    v_dot2c_f32_bf16 v22, v2, v147
    v_dot2c_f32_bf16 v23, v3, v147
    v_lshrrev_b32 v2, 16, v30
    v_and_b32 v3, 0xffff0000, v30
    v_dot2c_f32_bf16 v8, v2, v116
    v_dot2c_f32_bf16 v9, v3, v116
    v_dot2c_f32_bf16 v16, v2, v148
    v_dot2c_f32_bf16 v17, v3, v148
    v_dot2c_f32_bf16 v10, v2, v117
    v_dot2c_f32_bf16 v11, v3, v117
    v_dot2c_f32_bf16 v18, v2, v149
    v_dot2c_f32_bf16 v19, v3, v149
    v_dot2c_f32_bf16 v12, v2, v118
    v_dot2c_f32_bf16 v13, v3, v118
    v_dot2c_f32_bf16 v20, v2, v150
    v_dot2c_f32_bf16 v21, v3, v150
    v_dot2c_f32_bf16 v14, v2, v119
    v_dot2c_f32_bf16 v15, v3, v119
    v_dot2c_f32_bf16 v22, v2, v151
    v_dot2c_f32_bf16 v23, v3, v151
    v_and_b32 v2, 0xffff, v31
    v_lshlrev_b32 v3, 16, v31
    v_dot2c_f32_bf16 v8, v2, v120
    v_dot2c_f32_bf16 v9, v3, v120
    v_dot2c_f32_bf16 v16, v2, v152
    v_dot2c_f32_bf16 v17, v3, v152
    v_dot2c_f32_bf16 v10, v2, v121
    v_dot2c_f32_bf16 v11, v3, v121
    v_dot2c_f32_bf16 v18, v2, v153
    v_dot2c_f32_bf16 v19, v3, v153
    v_dot2c_f32_bf16 v12, v2, v122
    v_dot2c_f32_bf16 v13, v3, v122
    v_dot2c_f32_bf16 v20, v2, v154
    v_dot2c_f32_bf16 v21, v3, v154
    v_dot2c_f32_bf16 v14, v2, v123
    v_dot2c_f32_bf16 v15, v3, v123
    v_dot2c_f32_bf16 v22, v2, v155
    v_dot2c_f32_bf16 v23, v3, v155
    v_lshrrev_b32 v2, 16, v31
    v_and_b32 v3, 0xffff0000, v31
    v_dot2c_f32_bf16 v8, v2, v124
    v_dot2c_f32_bf16 v9, v3, v124
    v_dot2c_f32_bf16 v16, v2, v156
    v_dot2c_f32_bf16 v17, v3, v156
    v_dot2c_f32_bf16 v10, v2, v125
    v_dot2c_f32_bf16 v11, v3, v125
    v_dot2c_f32_bf16 v18, v2, v157
    v_dot2c_f32_bf16 v19, v3, v157
    v_dot2c_f32_bf16 v12, v2, v126
    v_dot2c_f32_bf16 v13, v3, v126
    v_dot2c_f32_bf16 v20, v2, v158
    v_dot2c_f32_bf16 v21, v3, v158
    v_dot2c_f32_bf16 v14, v2, v127
    v_dot2c_f32_bf16 v15, v3, v127
    v_dot2c_f32_bf16 v22, v2, v159
    v_dot2c_f32_bf16 v23, v3, v159
    s_lshl_b32 s91, s82, 6
    s_add_u32 s91, s91, s98
    s_lshl_b32 s91, s91, 4
    s_mul_i32 s89, s98, 224
    s_add_u32 s89, s89, s81
    s_lshl_b32 s89, s89, 7
    s_add_u32 s98, s98, 1
    s_and_b32 s98, s98, 7
    buffer_load_dwordx4 v[28:31], v5, s[48:51], s91 offen
    s_add_u32 s91, s91, 16
    buffer_load_dwordx4 v[96:99], v4, s[52:55], s89 offen
    buffer_load_dwordx4 v[128:131], v4, s[56:59], s89 offen
    buffer_load_dwordx4 v[100:103], v4, s[52:55], s89 offen offset:3584
    buffer_load_dwordx4 v[132:135], v4, s[56:59], s89 offen offset:3584
    s_add_u32 s89, s89, 7168
    buffer_load_dwordx4 v[104:107], v4, s[52:55], s89 offen
    buffer_load_dwordx4 v[136:139], v4, s[56:59], s89 offen
    buffer_load_dwordx4 v[108:111], v4, s[52:55], s89 offen offset:3584
    buffer_load_dwordx4 v[140:143], v4, s[56:59], s89 offen offset:3584
    s_add_u32 s89, s89, 7168
    buffer_load_dwordx4 v[112:115], v4, s[52:55], s89 offen
    buffer_load_dwordx4 v[144:147], v4, s[56:59], s89 offen
    buffer_load_dwordx4 v[116:119], v4, s[52:55], s89 offen offset:3584
    buffer_load_dwordx4 v[148:151], v4, s[56:59], s89 offen offset:3584
    s_add_u32 s89, s89, 7168
    buffer_load_dwordx4 v[120:123], v4, s[52:55], s89 offen
    buffer_load_dwordx4 v[152:155], v4, s[56:59], s89 offen
    buffer_load_dwordx4 v[124:127], v4, s[52:55], s89 offen offset:3584
    buffer_load_dwordx4 v[156:159], v4, s[56:59], s89 offen offset:3584
    s_add_u32 s89, s89, 7168
    s_add_u32 s88, s88, 1
    s_cmp_lt_u32 s88, 3
    s_cbranch_scc1 L_ffn_loop
    s_lshl_b32 s84, s81, 16
    s_add_u32 s85, s84, 4096
    s_add_u32 s86, s84, 8192
    s_add_u32 s87, s84, 12288
    s_waitcnt vmcnt(17)
    v_and_b32 v2, 0xffff, v24
    v_lshlrev_b32 v3, 16, v24
    v_dot2c_f32_bf16 v8, v2, v32
    v_dot2c_f32_bf16 v9, v3, v32
    v_dot2c_f32_bf16 v16, v2, v64
    v_dot2c_f32_bf16 v17, v3, v64
    v_dot2c_f32_bf16 v10, v2, v33
    v_dot2c_f32_bf16 v11, v3, v33
    v_dot2c_f32_bf16 v18, v2, v65
    v_dot2c_f32_bf16 v19, v3, v65
    v_dot2c_f32_bf16 v12, v2, v34
    v_dot2c_f32_bf16 v13, v3, v34
    v_dot2c_f32_bf16 v20, v2, v66
    v_dot2c_f32_bf16 v21, v3, v66
    v_dot2c_f32_bf16 v14, v2, v35
    v_dot2c_f32_bf16 v15, v3, v35
    v_dot2c_f32_bf16 v22, v2, v67
    v_dot2c_f32_bf16 v23, v3, v67
    v_lshrrev_b32 v2, 16, v24
    v_and_b32 v3, 0xffff0000, v24
    v_dot2c_f32_bf16 v8, v2, v36
    v_dot2c_f32_bf16 v9, v3, v36
    v_dot2c_f32_bf16 v16, v2, v68
    v_dot2c_f32_bf16 v17, v3, v68
    v_dot2c_f32_bf16 v10, v2, v37
    v_dot2c_f32_bf16 v11, v3, v37
    v_dot2c_f32_bf16 v18, v2, v69
    v_dot2c_f32_bf16 v19, v3, v69
    v_dot2c_f32_bf16 v12, v2, v38
    v_dot2c_f32_bf16 v13, v3, v38
    v_dot2c_f32_bf16 v20, v2, v70
    v_dot2c_f32_bf16 v21, v3, v70
    v_dot2c_f32_bf16 v14, v2, v39
    v_dot2c_f32_bf16 v15, v3, v39
    v_dot2c_f32_bf16 v22, v2, v71
    v_dot2c_f32_bf16 v23, v3, v71
    v_and_b32 v2, 0xffff, v25
    v_lshlrev_b32 v3, 16, v25
    v_dot2c_f32_bf16 v8, v2, v40
    v_dot2c_f32_bf16 v9, v3, v40
    v_dot2c_f32_bf16 v16, v2, v72
    v_dot2c_f32_bf16 v17, v3, v72
    v_dot2c_f32_bf16 v10, v2, v41
    v_dot2c_f32_bf16 v11, v3, v41
    v_dot2c_f32_bf16 v18, v2, v73
    v_dot2c_f32_bf16 v19, v3, v73
    v_dot2c_f32_bf16 v12, v2, v42
    v_dot2c_f32_bf16 v13, v3, v42
    v_dot2c_f32_bf16 v20, v2, v74
    v_dot2c_f32_bf16 v21, v3, v74
    v_dot2c_f32_bf16 v14, v2, v43
    v_dot2c_f32_bf16 v15, v3, v43
    v_dot2c_f32_bf16 v22, v2, v75
    v_dot2c_f32_bf16 v23, v3, v75
    v_lshrrev_b32 v2, 16, v25
    v_and_b32 v3, 0xffff0000, v25
    v_dot2c_f32_bf16 v8, v2, v44
    v_dot2c_f32_bf16 v9, v3, v44
    v_dot2c_f32_bf16 v16, v2, v76
    v_dot2c_f32_bf16 v17, v3, v76
    v_dot2c_f32_bf16 v10, v2, v45
    v_dot2c_f32_bf16 v11, v3, v45
    v_dot2c_f32_bf16 v18, v2, v77
    v_dot2c_f32_bf16 v19, v3, v77
    v_dot2c_f32_bf16 v12, v2, v46
    v_dot2c_f32_bf16 v13, v3, v46
    v_dot2c_f32_bf16 v20, v2, v78
    v_dot2c_f32_bf16 v21, v3, v78
    v_dot2c_f32_bf16 v14, v2, v47
    v_dot2c_f32_bf16 v15, v3, v47
    v_dot2c_f32_bf16 v22, v2, v79
    v_dot2c_f32_bf16 v23, v3, v79
    v_and_b32 v2, 0xffff, v26
    v_lshlrev_b32 v3, 16, v26
    v_dot2c_f32_bf16 v8, v2, v48
    v_dot2c_f32_bf16 v9, v3, v48
    v_dot2c_f32_bf16 v16, v2, v80
    v_dot2c_f32_bf16 v17, v3, v80
    v_dot2c_f32_bf16 v10, v2, v49
    v_dot2c_f32_bf16 v11, v3, v49
    v_dot2c_f32_bf16 v18, v2, v81
    v_dot2c_f32_bf16 v19, v3, v81
    v_dot2c_f32_bf16 v12, v2, v50
    v_dot2c_f32_bf16 v13, v3, v50
    v_dot2c_f32_bf16 v20, v2, v82
    v_dot2c_f32_bf16 v21, v3, v82
    v_dot2c_f32_bf16 v14, v2, v51
    v_dot2c_f32_bf16 v15, v3, v51
    v_dot2c_f32_bf16 v22, v2, v83
    v_dot2c_f32_bf16 v23, v3, v83
    v_lshrrev_b32 v2, 16, v26
    v_and_b32 v3, 0xffff0000, v26
    v_dot2c_f32_bf16 v8, v2, v52
    v_dot2c_f32_bf16 v9, v3, v52
    v_dot2c_f32_bf16 v16, v2, v84
    v_dot2c_f32_bf16 v17, v3, v84
    v_dot2c_f32_bf16 v10, v2, v53
    v_dot2c_f32_bf16 v11, v3, v53
    v_dot2c_f32_bf16 v18, v2, v85
    v_dot2c_f32_bf16 v19, v3, v85
    v_dot2c_f32_bf16 v12, v2, v54
    v_dot2c_f32_bf16 v13, v3, v54
    v_dot2c_f32_bf16 v20, v2, v86
    v_dot2c_f32_bf16 v21, v3, v86
    v_dot2c_f32_bf16 v14, v2, v55
    v_dot2c_f32_bf16 v15, v3, v55
    v_dot2c_f32_bf16 v22, v2, v87
    v_dot2c_f32_bf16 v23, v3, v87
    v_and_b32 v2, 0xffff, v27
    v_lshlrev_b32 v3, 16, v27
    v_dot2c_f32_bf16 v8, v2, v56
    v_dot2c_f32_bf16 v9, v3, v56
    v_dot2c_f32_bf16 v16, v2, v88
    v_dot2c_f32_bf16 v17, v3, v88
    v_dot2c_f32_bf16 v10, v2, v57
    v_dot2c_f32_bf16 v11, v3, v57
    v_dot2c_f32_bf16 v18, v2, v89
    v_dot2c_f32_bf16 v19, v3, v89
    v_dot2c_f32_bf16 v12, v2, v58
    v_dot2c_f32_bf16 v13, v3, v58
    v_dot2c_f32_bf16 v20, v2, v90
    v_dot2c_f32_bf16 v21, v3, v90
    v_dot2c_f32_bf16 v14, v2, v59
    v_dot2c_f32_bf16 v15, v3, v59
    v_dot2c_f32_bf16 v22, v2, v91
    v_dot2c_f32_bf16 v23, v3, v91
    v_lshrrev_b32 v2, 16, v27
    v_and_b32 v3, 0xffff0000, v27
    v_dot2c_f32_bf16 v8, v2, v60
    v_dot2c_f32_bf16 v9, v3, v60
    v_dot2c_f32_bf16 v16, v2, v92
    v_dot2c_f32_bf16 v17, v3, v92
    v_dot2c_f32_bf16 v10, v2, v61
    v_dot2c_f32_bf16 v11, v3, v61
    v_dot2c_f32_bf16 v18, v2, v93
    v_dot2c_f32_bf16 v19, v3, v93
    v_dot2c_f32_bf16 v12, v2, v62
    v_dot2c_f32_bf16 v13, v3, v62
    v_dot2c_f32_bf16 v20, v2, v94
    v_dot2c_f32_bf16 v21, v3, v94
    v_dot2c_f32_bf16 v14, v2, v63
    v_dot2c_f32_bf16 v15, v3, v63
    v_dot2c_f32_bf16 v22, v2, v95
    v_dot2c_f32_bf16 v23, v3, v95
    buffer_load_dwordx4 v[32:35], v1, s[60:63], s84 offen offset:0
    buffer_load_dwordx4 v[36:39], v1, s[60:63], s84 offen offset:1024
    buffer_load_dwordx4 v[40:43], v1, s[60:63], s84 offen offset:2048
    buffer_load_dwordx4 v[44:47], v1, s[60:63], s84 offen offset:3072
    buffer_load_dwordx4 v[48:51], v1, s[60:63], s85 offen offset:0
    buffer_load_dwordx4 v[52:55], v1, s[60:63], s85 offen offset:1024
    buffer_load_dwordx4 v[56:59], v1, s[60:63], s85 offen offset:2048
    buffer_load_dwordx4 v[60:63], v1, s[60:63], s85 offen offset:3072
    buffer_load_dwordx4 v[64:67], v1, s[60:63], s86 offen offset:0
    buffer_load_dwordx4 v[68:71], v1, s[60:63], s86 offen offset:1024
    buffer_load_dwordx4 v[72:75], v1, s[60:63], s86 offen offset:2048
    buffer_load_dwordx4 v[76:79], v1, s[60:63], s86 offen offset:3072
    buffer_load_dwordx4 v[80:83], v1, s[60:63], s87 offen offset:0
    buffer_load_dwordx4 v[84:87], v1, s[60:63], s87 offen offset:1024
    buffer_load_dwordx4 v[88:91], v1, s[60:63], s87 offen offset:2048
    buffer_load_dwordx4 v[92:95], v1, s[60:63], s87 offen offset:3072
    s_add_u32 s84, s84, 16384
    s_add_u32 s85, s85, 16384
    s_add_u32 s86, s86, 16384
    s_add_u32 s87, s87, 16384
    s_waitcnt vmcnt(16)
    v_and_b32 v2, 0xffff, v28
    v_lshlrev_b32 v3, 16, v28
    v_dot2c_f32_bf16 v8, v2, v96
    v_dot2c_f32_bf16 v9, v3, v96
    v_dot2c_f32_bf16 v16, v2, v128
    v_dot2c_f32_bf16 v17, v3, v128
    v_dot2c_f32_bf16 v10, v2, v97
    v_dot2c_f32_bf16 v11, v3, v97
    v_dot2c_f32_bf16 v18, v2, v129
    v_dot2c_f32_bf16 v19, v3, v129
    v_dot2c_f32_bf16 v12, v2, v98
    v_dot2c_f32_bf16 v13, v3, v98
    v_dot2c_f32_bf16 v20, v2, v130
    v_dot2c_f32_bf16 v21, v3, v130
    v_dot2c_f32_bf16 v14, v2, v99
    v_dot2c_f32_bf16 v15, v3, v99
    v_dot2c_f32_bf16 v22, v2, v131
    v_dot2c_f32_bf16 v23, v3, v131
    v_lshrrev_b32 v2, 16, v28
    v_and_b32 v3, 0xffff0000, v28
    v_dot2c_f32_bf16 v8, v2, v100
    v_dot2c_f32_bf16 v9, v3, v100
    v_dot2c_f32_bf16 v16, v2, v132
    v_dot2c_f32_bf16 v17, v3, v132
    v_dot2c_f32_bf16 v10, v2, v101
    v_dot2c_f32_bf16 v11, v3, v101
    v_dot2c_f32_bf16 v18, v2, v133
    v_dot2c_f32_bf16 v19, v3, v133
    v_dot2c_f32_bf16 v12, v2, v102
    v_dot2c_f32_bf16 v13, v3, v102
    v_dot2c_f32_bf16 v20, v2, v134
    v_dot2c_f32_bf16 v21, v3, v134
    v_dot2c_f32_bf16 v14, v2, v103
    v_dot2c_f32_bf16 v15, v3, v103
    v_dot2c_f32_bf16 v22, v2, v135
    v_dot2c_f32_bf16 v23, v3, v135
    v_and_b32 v2, 0xffff, v29
    v_lshlrev_b32 v3, 16, v29
    v_dot2c_f32_bf16 v8, v2, v104
    v_dot2c_f32_bf16 v9, v3, v104
    v_dot2c_f32_bf16 v16, v2, v136
    v_dot2c_f32_bf16 v17, v3, v136
    v_dot2c_f32_bf16 v10, v2, v105
    v_dot2c_f32_bf16 v11, v3, v105
    v_dot2c_f32_bf16 v18, v2, v137
    v_dot2c_f32_bf16 v19, v3, v137
    v_dot2c_f32_bf16 v12, v2, v106
    v_dot2c_f32_bf16 v13, v3, v106
    v_dot2c_f32_bf16 v20, v2, v138
    v_dot2c_f32_bf16 v21, v3, v138
    v_dot2c_f32_bf16 v14, v2, v107
    v_dot2c_f32_bf16 v15, v3, v107
    v_dot2c_f32_bf16 v22, v2, v139
    v_dot2c_f32_bf16 v23, v3, v139
    v_lshrrev_b32 v2, 16, v29
    v_and_b32 v3, 0xffff0000, v29
    v_dot2c_f32_bf16 v8, v2, v108
    v_dot2c_f32_bf16 v9, v3, v108
    v_dot2c_f32_bf16 v16, v2, v140
    v_dot2c_f32_bf16 v17, v3, v140
    v_dot2c_f32_bf16 v10, v2, v109
    v_dot2c_f32_bf16 v11, v3, v109
    v_dot2c_f32_bf16 v18, v2, v141
    v_dot2c_f32_bf16 v19, v3, v141
    v_dot2c_f32_bf16 v12, v2, v110
    v_dot2c_f32_bf16 v13, v3, v110
    v_dot2c_f32_bf16 v20, v2, v142
    v_dot2c_f32_bf16 v21, v3, v142
    v_dot2c_f32_bf16 v14, v2, v111
    v_dot2c_f32_bf16 v15, v3, v111
    v_dot2c_f32_bf16 v22, v2, v143
    v_dot2c_f32_bf16 v23, v3, v143
    v_and_b32 v2, 0xffff, v30
    v_lshlrev_b32 v3, 16, v30
    v_dot2c_f32_bf16 v8, v2, v112
    v_dot2c_f32_bf16 v9, v3, v112
    v_dot2c_f32_bf16 v16, v2, v144
    v_dot2c_f32_bf16 v17, v3, v144
    v_dot2c_f32_bf16 v10, v2, v113
    v_dot2c_f32_bf16 v11, v3, v113
    v_dot2c_f32_bf16 v18, v2, v145
    v_dot2c_f32_bf16 v19, v3, v145
    v_dot2c_f32_bf16 v12, v2, v114
    v_dot2c_f32_bf16 v13, v3, v114
    v_dot2c_f32_bf16 v20, v2, v146
    v_dot2c_f32_bf16 v21, v3, v146
    v_dot2c_f32_bf16 v14, v2, v115
    v_dot2c_f32_bf16 v15, v3, v115
    v_dot2c_f32_bf16 v22, v2, v147
    v_dot2c_f32_bf16 v23, v3, v147
    v_lshrrev_b32 v2, 16, v30
    v_and_b32 v3, 0xffff0000, v30
    v_dot2c_f32_bf16 v8, v2, v116
    v_dot2c_f32_bf16 v9, v3, v116
    v_dot2c_f32_bf16 v16, v2, v148
    v_dot2c_f32_bf16 v17, v3, v148
    v_dot2c_f32_bf16 v10, v2, v117
    v_dot2c_f32_bf16 v11, v3, v117
    v_dot2c_f32_bf16 v18, v2, v149
    v_dot2c_f32_bf16 v19, v3, v149
    v_dot2c_f32_bf16 v12, v2, v118
    v_dot2c_f32_bf16 v13, v3, v118
    v_dot2c_f32_bf16 v20, v2, v150
    v_dot2c_f32_bf16 v21, v3, v150
    v_dot2c_f32_bf16 v14, v2, v119
    v_dot2c_f32_bf16 v15, v3, v119
    v_dot2c_f32_bf16 v22, v2, v151
    v_dot2c_f32_bf16 v23, v3, v151
    v_and_b32 v2, 0xffff, v31
    v_lshlrev_b32 v3, 16, v31
    v_dot2c_f32_bf16 v8, v2, v120
    v_dot2c_f32_bf16 v9, v3, v120
    v_dot2c_f32_bf16 v16, v2, v152
    v_dot2c_f32_bf16 v17, v3, v152
    v_dot2c_f32_bf16 v10, v2, v121
    v_dot2c_f32_bf16 v11, v3, v121
    v_dot2c_f32_bf16 v18, v2, v153
    v_dot2c_f32_bf16 v19, v3, v153
    v_dot2c_f32_bf16 v12, v2, v122
    v_dot2c_f32_bf16 v13, v3, v122
    v_dot2c_f32_bf16 v20, v2, v154
    v_dot2c_f32_bf16 v21, v3, v154
    v_dot2c_f32_bf16 v14, v2, v123
    v_dot2c_f32_bf16 v15, v3, v123
    v_dot2c_f32_bf16 v22, v2, v155
    v_dot2c_f32_bf16 v23, v3, v155
    v_lshrrev_b32 v2, 16, v31
    v_and_b32 v3, 0xffff0000, v31
    v_dot2c_f32_bf16 v8, v2, v124
    v_dot2c_f32_bf16 v9, v3, v124
    v_dot2c_f32_bf16 v16, v2, v156
    v_dot2c_f32_bf16 v17, v3, v156
    v_dot2c_f32_bf16 v10, v2, v125
    v_dot2c_f32_bf16 v11, v3, v125
    v_dot2c_f32_bf16 v18, v2, v157
    v_dot2c_f32_bf16 v19, v3, v157
    v_dot2c_f32_bf16 v12, v2, v126
    v_dot2c_f32_bf16 v13, v3, v126
    v_dot2c_f32_bf16 v20, v2, v158
    v_dot2c_f32_bf16 v21, v3, v158
    v_dot2c_f32_bf16 v14, v2, v127
    v_dot2c_f32_bf16 v15, v3, v127
    v_dot2c_f32_bf16 v22, v2, v159
    v_dot2c_f32_bf16 v23, v3, v159
    buffer_load_dwordx4 v[96:99], v1, s[60:63], s84 offen offset:0
    buffer_load_dwordx4 v[100:103], v1, s[60:63], s84 offen offset:1024
    buffer_load_dwordx4 v[104:107], v1, s[60:63], s84 offen offset:2048
    buffer_load_dwordx4 v[108:111], v1, s[60:63], s84 offen offset:3072
    buffer_load_dwordx4 v[112:115], v1, s[60:63], s85 offen offset:0
    buffer_load_dwordx4 v[116:119], v1, s[60:63], s85 offen offset:1024
    buffer_load_dwordx4 v[120:123], v1, s[60:63], s85 offen offset:2048
    buffer_load_dwordx4 v[124:127], v1, s[60:63], s85 offen offset:3072
    buffer_load_dwordx4 v[128:131], v1, s[60:63], s86 offen offset:0
    buffer_load_dwordx4 v[132:135], v1, s[60:63], s86 offen offset:1024
    buffer_load_dwordx4 v[136:139], v1, s[60:63], s86 offen offset:2048
    buffer_load_dwordx4 v[140:143], v1, s[60:63], s86 offen offset:3072
    buffer_load_dwordx4 v[144:147], v1, s[60:63], s87 offen offset:0
    buffer_load_dwordx4 v[148:151], v1, s[60:63], s87 offen offset:1024
    buffer_load_dwordx4 v[152:155], v1, s[60:63], s87 offen offset:2048
    buffer_load_dwordx4 v[156:159], v1, s[60:63], s87 offen offset:3072
    s_add_u32 s84, s84, 16384
    s_add_u32 s85, s85, 16384
    s_add_u32 s86, s86, 16384
    s_add_u32 s87, s87, 16384
    s_nop 2
    v_add_f32_dpp v8, v8, v8 row_ror:8 row_mask:0xf bank_mask:0xf
    v_add_f32_dpp v9, v9, v9 row_ror:8 row_mask:0xf bank_mask:0xf
    v_add_f32_dpp v10, v10, v10 row_ror:8 row_mask:0xf bank_mask:0xf
    v_add_f32_dpp v11, v11, v11 row_ror:8 row_mask:0xf bank_mask:0xf
    v_add_f32_dpp v12, v12, v12 row_ror:8 row_mask:0xf bank_mask:0xf
    v_add_f32_dpp v13, v13, v13 row_ror:8 row_mask:0xf bank_mask:0xf
    v_add_f32_dpp v14, v14, v14 row_ror:8 row_mask:0xf bank_mask:0xf
    v_add_f32_dpp v15, v15, v15 row_ror:8 row_mask:0xf bank_mask:0xf
    v_add_f32_dpp v16, v16, v16 row_ror:8 row_mask:0xf bank_mask:0xf
    v_add_f32_dpp v17, v17, v17 row_ror:8 row_mask:0xf bank_mask:0xf
    v_add_f32_dpp v18, v18, v18 row_ror:8 row_mask:0xf bank_mask:0xf
    v_add_f32_dpp v19, v19, v19 row_ror:8 row_mask:0xf bank_mask:0xf
    v_add_f32_dpp v20, v20, v20 row_ror:8 row_mask:0xf bank_mask:0xf
    v_add_f32_dpp v21, v21, v21 row_ror:8 row_mask:0xf bank_mask:0xf
    v_add_f32_dpp v22, v22, v22 row_ror:8 row_mask:0xf bank_mask:0xf
    v_add_f32_dpp v23, v23, v23 row_ror:8 row_mask:0xf bank_mask:0xf
    v_mov_b32 v7, v8
    s_nop 1
    v_permlane32_swap_b32 v8, v7
    v_add_f32 v8, v8, v7
    v_mov_b32 v7, v8
    s_nop 1
    v_permlane16_swap_b32 v8, v7
    v_add_f32 v8, v8, v7
    v_mov_b32 v7, v9
    s_nop 1
    v_permlane32_swap_b32 v9, v7
    v_add_f32 v9, v9, v7
    v_mov_b32 v7, v9
    s_nop 1
    v_permlane16_swap_b32 v9, v7
    v_add_f32 v9, v9, v7
    v_mov_b32 v7, v10
    s_nop 1
    v_permlane32_swap_b32 v10, v7
    v_add_f32 v10, v10, v7
    v_mov_b32 v7, v10
    s_nop 1
    v_permlane16_swap_b32 v10, v7
    v_add_f32 v10, v10, v7
    v_mov_b32 v7, v11
    s_nop 1
    v_permlane32_swap_b32 v11, v7
    v_add_f32 v11, v11, v7
    v_mov_b32 v7, v11
    s_nop 1
    v_permlane16_swap_b32 v11, v7
    v_add_f32 v11, v11, v7
    v_mov_b32 v7, v12
    s_nop 1
    v_permlane32_swap_b32 v12, v7
    v_add_f32 v12, v12, v7
    v_mov_b32 v7, v12
    s_nop 1
    v_permlane16_swap_b32 v12, v7
    v_add_f32 v12, v12, v7
    v_mov_b32 v7, v13
    s_nop 1
    v_permlane32_swap_b32 v13, v7
    v_add_f32 v13, v13, v7
    v_mov_b32 v7, v13
    s_nop 1
    v_permlane16_swap_b32 v13, v7
    v_add_f32 v13, v13, v7
    v_mov_b32 v7, v14
    s_nop 1
    v_permlane32_swap_b32 v14, v7
    v_add_f32 v14, v14, v7
    v_mov_b32 v7, v14
    s_nop 1
    v_permlane16_swap_b32 v14, v7
    v_add_f32 v14, v14, v7
    v_mov_b32 v7, v15
    s_nop 1
    v_permlane32_swap_b32 v15, v7
    v_add_f32 v15, v15, v7
    v_mov_b32 v7, v15
    s_nop 1
    v_permlane16_swap_b32 v15, v7
    v_add_f32 v15, v15, v7
    v_mov_b32 v7, v16
    s_nop 1
    v_permlane32_swap_b32 v16, v7
    v_add_f32 v16, v16, v7
    v_mov_b32 v7, v16
    s_nop 1
    v_permlane16_swap_b32 v16, v7
    v_add_f32 v16, v16, v7
    v_mov_b32 v7, v17
    s_nop 1
    v_permlane32_swap_b32 v17, v7
    v_add_f32 v17, v17, v7
    v_mov_b32 v7, v17
    s_nop 1
    v_permlane16_swap_b32 v17, v7
    v_add_f32 v17, v17, v7
    v_mov_b32 v7, v18
    s_nop 1
    v_permlane32_swap_b32 v18, v7
    v_add_f32 v18, v18, v7
    v_mov_b32 v7, v18
    s_nop 1
    v_permlane16_swap_b32 v18, v7
    v_add_f32 v18, v18, v7
    v_mov_b32 v7, v19
    s_nop 1
    v_permlane32_swap_b32 v19, v7
    v_add_f32 v19, v19, v7
    v_mov_b32 v7, v19
    s_nop 1
    v_permlane16_swap_b32 v19, v7
    v_add_f32 v19, v19, v7
    v_mov_b32 v7, v20
    s_nop 1
    v_permlane32_swap_b32 v20, v7
    v_add_f32 v20, v20, v7
    v_mov_b32 v7, v20
    s_nop 1
    v_permlane16_swap_b32 v20, v7
    v_add_f32 v20, v20, v7
    v_mov_b32 v7, v21
    s_nop 1
    v_permlane32_swap_b32 v21, v7
    v_add_f32 v21, v21, v7
    v_mov_b32 v7, v21
    s_nop 1
    v_permlane16_swap_b32 v21, v7
    v_add_f32 v21, v21, v7
    v_mov_b32 v7, v22
    s_nop 1
    v_permlane32_swap_b32 v22, v7
    v_add_f32 v22, v22, v7
    v_mov_b32 v7, v22
    s_nop 1
    v_permlane16_swap_b32 v22, v7
    v_add_f32 v22, v22, v7
    v_mov_b32 v7, v23
    s_nop 1
    v_permlane32_swap_b32 v23, v7
    v_add_f32 v23, v23, v7
    v_mov_b32 v7, v23
    s_nop 1
    v_permlane16_swap_b32 v23, v7
    v_add_f32 v23, v23, v7
    v_mul_f32 v24, 0xbfb8aa3b, v8
    v_mul_f32 v25, 0xbfb8aa3b, v9
    v_mul_f32 v26, 0xbfb8aa3b, v10
    v_mul_f32 v27, 0xbfb8aa3b, v11
    v_mul_f32 v28, 0xbfb8aa3b, v12
    v_mul_f32 v29, 0xbfb8aa3b, v13
    v_mul_f32 v30, 0xbfb8aa3b, v14
    v_mul_f32 v31, 0xbfb8aa3b, v15
    v_exp_f32 v24, v24
    v_exp_f32 v25, v25
    v_exp_f32 v26, v26
    v_exp_f32 v27, v27
    v_exp_f32 v28, v28
    v_exp_f32 v29, v29
    v_exp_f32 v30, v30
    v_exp_f32 v31, v31
    s_nop 0
    v_add_f32 v24, 1.0, v24
    v_add_f32 v25, 1.0, v25
    v_add_f32 v26, 1.0, v26
    v_add_f32 v27, 1.0, v27
    v_add_f32 v28, 1.0, v28
    v_add_f32 v29, 1.0, v29
    v_add_f32 v30, 1.0, v30
    v_add_f32 v31, 1.0, v31
    v_rcp_f32 v24, v24
    v_rcp_f32 v25, v25
    v_rcp_f32 v26, v26
    v_rcp_f32 v27, v27
    v_rcp_f32 v28, v28
    v_rcp_f32 v29, v29
    v_rcp_f32 v30, v30
    v_rcp_f32 v31, v31
    s_nop 0
    v_mul_f32 v24, v24, v8
    v_mul_f32 v25, v25, v9
    v_mul_f32 v26, v26, v10
    v_mul_f32 v27, v27, v11
    v_mul_f32 v28, v28, v12
    v_mul_f32 v29, v29, v13
    v_mul_f32 v30, v30, v14
    v_mul_f32 v31, v31, v15
    v_mul_f32 v24, v24, v16
    v_mul_f32 v25, v25, v17
    v_mul_f32 v26, v26, v18
    v_mul_f32 v27, v27, v19
    v_mul_f32 v28, v28, v20
    v_mul_f32 v29, v29, v21
    v_mul_f32 v30, v30, v22
    v_mul_f32 v31, v31, v23
    v_cvt_pk_bf16_f32 v8, v24, 0
    v_cvt_pk_bf16_f32 v16, 0, v24
    v_cvt_pk_bf16_f32 v9, v25, 0
    v_cvt_pk_bf16_f32 v17, 0, v25
    v_cvt_pk_bf16_f32 v10, v26, 0
    v_cvt_pk_bf16_f32 v18, 0, v26
    v_cvt_pk_bf16_f32 v11, v27, 0
    v_cvt_pk_bf16_f32 v19, 0, v27
    v_cvt_pk_bf16_f32 v12, v28, 0
    v_cvt_pk_bf16_f32 v20, 0, v28
    v_cvt_pk_bf16_f32 v13, v29, 0
    v_cvt_pk_bf16_f32 v21, 0, v29
    v_cvt_pk_bf16_f32 v14, v30, 0
    v_cvt_pk_bf16_f32 v22, 0, v30
    v_cvt_pk_bf16_f32 v15, v31, 0
    v_cvt_pk_bf16_f32 v23, 0, v31
    v_mov_b32 v160, 0
    v_mov_b32 v161, 0
    v_mov_b32 v162, 0
    v_mov_b32 v163, 0
    v_mov_b32 v164, 0
    v_mov_b32 v165, 0
    v_mov_b32 v166, 0
    v_mov_b32 v167, 0
    s_waitcnt vmcnt(31)
    v_dot2c_f32_bf16_dpp v160, v8, v32 row_newbcast:0 row_mask:0xf bank_mask:0xf
    v_dot2c_f32_bf16_dpp v161, v16, v32 row_newbcast:0 row_mask:0xf bank_mask:0xf
    v_dot2c_f32_bf16_dpp v162, v8, v33 row_newbcast:0 row_mask:0xf bank_mask:0xf
    v_dot2c_f32_bf16_dpp v163, v16, v33 row_newbcast:0 row_mask:0xf bank_mask:0xf
    v_dot2c_f32_bf16_dpp v164, v8, v34 row_newbcast:0 row_mask:0xf bank_mask:0xf
    v_dot2c_f32_bf16_dpp v165, v16, v34 row_newbcast:0 row_mask:0xf bank_mask:0xf
    v_dot2c_f32_bf16_dpp v166, v8, v35 row_newbcast:0 row_mask:0xf bank_mask:0xf
    v_dot2c_f32_bf16_dpp v167, v16, v35 row_newbcast:0 row_mask:0xf bank_mask:0xf
    buffer_load_dwordx4 v[32:35], v1, s[60:63], s84 offen offset:0
    s_waitcnt vmcnt(31)
    v_dot2c_f32_bf16_dpp v160, v9, v36 row_newbcast:0 row_mask:0xf bank_mask:0xf
    v_dot2c_f32_bf16_dpp v161, v17, v36 row_newbcast:0 row_mask:0xf bank_mask:0xf
    v_dot2c_f32_bf16_dpp v162, v9, v37 row_newbcast:0 row_mask:0xf bank_mask:0xf
    v_dot2c_f32_bf16_dpp v163, v17, v37 row_newbcast:0 row_mask:0xf bank_mask:0xf
    v_dot2c_f32_bf16_dpp v164, v9, v38 row_newbcast:0 row_mask:0xf bank_mask:0xf
    v_dot2c_f32_bf16_dpp v165, v17, v38 row_newbcast:0 row_mask:0xf bank_mask:0xf
    v_dot2c_f32_bf16_dpp v166, v9, v39 row_newbcast:0 row_mask:0xf bank_mask:0xf
    v_dot2c_f32_bf16_dpp v167, v17, v39 row_newbcast:0 row_mask:0xf bank_mask:0xf
    buffer_load_dwordx4 v[36:39], v1, s[60:63], s84 offen offset:1024
    s_waitcnt vmcnt(31)
    v_dot2c_f32_bf16_dpp v160, v10, v40 row_newbcast:0 row_mask:0xf bank_mask:0xf
    v_dot2c_f32_bf16_dpp v161, v18, v40 row_newbcast:0 row_mask:0xf bank_mask:0xf
    v_dot2c_f32_bf16_dpp v162, v10, v41 row_newbcast:0 row_mask:0xf bank_mask:0xf
    v_dot2c_f32_bf16_dpp v163, v18, v41 row_newbcast:0 row_mask:0xf bank_mask:0xf
    v_dot2c_f32_bf16_dpp v164, v10, v42 row_newbcast:0 row_mask:0xf bank_mask:0xf
    v_dot2c_f32_bf16_dpp v165, v18, v42 row_newbcast:0 row_mask:0xf bank_mask:0xf
    v_dot2c_f32_bf16_dpp v166, v10, v43 row_newbcast:0 row_mask:0xf bank_mask:0xf
    v_dot2c_f32_bf16_dpp v167, v18, v43 row_newbcast:0 row_mask:0xf bank_mask:0xf
    buffer_load_dwordx4 v[40:43], v1, s[60:63], s84 offen offset:2048
    s_waitcnt vmcnt(31)
    v_dot2c_f32_bf16_dpp v160, v11, v44 row_newbcast:0 row_mask:0xf bank_mask:0xf
    v_dot2c_f32_bf16_dpp v161, v19, v44 row_newbcast:0 row_mask:0xf bank_mask:0xf
    v_dot2c_f32_bf16_dpp v162, v11, v45 row_newbcast:0 row_mask:0xf bank_mask:0xf
    v_dot2c_f32_bf16_dpp v163, v19, v45 row_newbcast:0 row_mask:0xf bank_mask:0xf
    v_dot2c_f32_bf16_dpp v164, v11, v46 row_newbcast:0 row_mask:0xf bank_mask:0xf
    v_dot2c_f32_bf16_dpp v165, v19, v46 row_newbcast:0 row_mask:0xf bank_mask:0xf
    v_dot2c_f32_bf16_dpp v166, v11, v47 row_newbcast:0 row_mask:0xf bank_mask:0xf
    v_dot2c_f32_bf16_dpp v167, v19, v47 row_newbcast:0 row_mask:0xf bank_mask:0xf
    buffer_load_dwordx4 v[44:47], v1, s[60:63], s84 offen offset:3072
    s_waitcnt vmcnt(31)
    v_dot2c_f32_bf16_dpp v160, v12, v48 row_newbcast:0 row_mask:0xf bank_mask:0xf
    v_dot2c_f32_bf16_dpp v161, v20, v48 row_newbcast:0 row_mask:0xf bank_mask:0xf
    v_dot2c_f32_bf16_dpp v162, v12, v49 row_newbcast:0 row_mask:0xf bank_mask:0xf
    v_dot2c_f32_bf16_dpp v163, v20, v49 row_newbcast:0 row_mask:0xf bank_mask:0xf
    v_dot2c_f32_bf16_dpp v164, v12, v50 row_newbcast:0 row_mask:0xf bank_mask:0xf
    v_dot2c_f32_bf16_dpp v165, v20, v50 row_newbcast:0 row_mask:0xf bank_mask:0xf
    v_dot2c_f32_bf16_dpp v166, v12, v51 row_newbcast:0 row_mask:0xf bank_mask:0xf
    v_dot2c_f32_bf16_dpp v167, v20, v51 row_newbcast:0 row_mask:0xf bank_mask:0xf
    buffer_load_dwordx4 v[48:51], v1, s[60:63], s85 offen offset:0
    s_waitcnt vmcnt(31)
    v_dot2c_f32_bf16_dpp v160, v13, v52 row_newbcast:0 row_mask:0xf bank_mask:0xf
    v_dot2c_f32_bf16_dpp v161, v21, v52 row_newbcast:0 row_mask:0xf bank_mask:0xf
    v_dot2c_f32_bf16_dpp v162, v13, v53 row_newbcast:0 row_mask:0xf bank_mask:0xf
    v_dot2c_f32_bf16_dpp v163, v21, v53 row_newbcast:0 row_mask:0xf bank_mask:0xf
    v_dot2c_f32_bf16_dpp v164, v13, v54 row_newbcast:0 row_mask:0xf bank_mask:0xf
    v_dot2c_f32_bf16_dpp v165, v21, v54 row_newbcast:0 row_mask:0xf bank_mask:0xf
    v_dot2c_f32_bf16_dpp v166, v13, v55 row_newbcast:0 row_mask:0xf bank_mask:0xf
    v_dot2c_f32_bf16_dpp v167, v21, v55 row_newbcast:0 row_mask:0xf bank_mask:0xf
    buffer_load_dwordx4 v[52:55], v1, s[60:63], s85 offen offset:1024
    s_waitcnt vmcnt(31)
    v_dot2c_f32_bf16_dpp v160, v14, v56 row_newbcast:0 row_mask:0xf bank_mask:0xf
    v_dot2c_f32_bf16_dpp v161, v22, v56 row_newbcast:0 row_mask:0xf bank_mask:0xf
    v_dot2c_f32_bf16_dpp v162, v14, v57 row_newbcast:0 row_mask:0xf bank_mask:0xf
    v_dot2c_f32_bf16_dpp v163, v22, v57 row_newbcast:0 row_mask:0xf bank_mask:0xf
    v_dot2c_f32_bf16_dpp v164, v14, v58 row_newbcast:0 row_mask:0xf bank_mask:0xf
    v_dot2c_f32_bf16_dpp v165, v22, v58 row_newbcast:0 row_mask:0xf bank_mask:0xf
    v_dot2c_f32_bf16_dpp v166, v14, v59 row_newbcast:0 row_mask:0xf bank_mask:0xf
    v_dot2c_f32_bf16_dpp v167, v22, v59 row_newbcast:0 row_mask:0xf bank_mask:0xf
    buffer_load_dwordx4 v[56:59], v1, s[60:63], s85 offen offset:2048
    s_waitcnt vmcnt(31)
    v_dot2c_f32_bf16_dpp v160, v15, v60 row_newbcast:0 row_mask:0xf bank_mask:0xf
    v_dot2c_f32_bf16_dpp v161, v23, v60 row_newbcast:0 row_mask:0xf bank_mask:0xf
    v_dot2c_f32_bf16_dpp v162, v15, v61 row_newbcast:0 row_mask:0xf bank_mask:0xf
    v_dot2c_f32_bf16_dpp v163, v23, v61 row_newbcast:0 row_mask:0xf bank_mask:0xf
    v_dot2c_f32_bf16_dpp v164, v15, v62 row_newbcast:0 row_mask:0xf bank_mask:0xf
    v_dot2c_f32_bf16_dpp v165, v23, v62 row_newbcast:0 row_mask:0xf bank_mask:0xf
    v_dot2c_f32_bf16_dpp v166, v15, v63 row_newbcast:0 row_mask:0xf bank_mask:0xf
    v_dot2c_f32_bf16_dpp v167, v23, v63 row_newbcast:0 row_mask:0xf bank_mask:0xf
    buffer_load_dwordx4 v[60:63], v1, s[60:63], s85 offen offset:3072
    s_waitcnt vmcnt(31)
    v_dot2c_f32_bf16_dpp v160, v8, v64 row_newbcast:1 row_mask:0xf bank_mask:0xf
    v_dot2c_f32_bf16_dpp v161, v16, v64 row_newbcast:1 row_mask:0xf bank_mask:0xf
    v_dot2c_f32_bf16_dpp v162, v8, v65 row_newbcast:1 row_mask:0xf bank_mask:0xf
    v_dot2c_f32_bf16_dpp v163, v16, v65 row_newbcast:1 row_mask:0xf bank_mask:0xf
    v_dot2c_f32_bf16_dpp v164, v8, v66 row_newbcast:1 row_mask:0xf bank_mask:0xf
    v_dot2c_f32_bf16_dpp v165, v16, v66 row_newbcast:1 row_mask:0xf bank_mask:0xf
    v_dot2c_f32_bf16_dpp v166, v8, v67 row_newbcast:1 row_mask:0xf bank_mask:0xf
    v_dot2c_f32_bf16_dpp v167, v16, v67 row_newbcast:1 row_mask:0xf bank_mask:0xf
    buffer_load_dwordx4 v[64:67], v1, s[60:63], s86 offen offset:0
    s_waitcnt vmcnt(31)
    v_dot2c_f32_bf16_dpp v160, v9, v68 row_newbcast:1 row_mask:0xf bank_mask:0xf
    v_dot2c_f32_bf16_dpp v161, v17, v68 row_newbcast:1 row_mask:0xf bank_mask:0xf
    v_dot2c_f32_bf16_dpp v162, v9, v69 row_newbcast:1 row_mask:0xf bank_mask:0xf
    v_dot2c_f32_bf16_dpp v163, v17, v69 row_newbcast:1 row_mask:0xf bank_mask:0xf
    v_dot2c_f32_bf16_dpp v164, v9, v70 row_newbcast:1 row_mask:0xf bank_mask:0xf
    v_dot2c_f32_bf16_dpp v165, v17, v70 row_newbcast:1 row_mask:0xf bank_mask:0xf
    v_dot2c_f32_bf16_dpp v166, v9, v71 row_newbcast:1 row_mask:0xf bank_mask:0xf
    v_dot2c_f32_bf16_dpp v167, v17, v71 row_newbcast:1 row_mask:0xf bank_mask:0xf
    buffer_load_dwordx4 v[68:71], v1, s[60:63], s86 offen offset:1024
    s_waitcnt vmcnt(31)
    v_dot2c_f32_bf16_dpp v160, v10, v72 row_newbcast:1 row_mask:0xf bank_mask:0xf
    v_dot2c_f32_bf16_dpp v161, v18, v72 row_newbcast:1 row_mask:0xf bank_mask:0xf
    v_dot2c_f32_bf16_dpp v162, v10, v73 row_newbcast:1 row_mask:0xf bank_mask:0xf
    v_dot2c_f32_bf16_dpp v163, v18, v73 row_newbcast:1 row_mask:0xf bank_mask:0xf
    v_dot2c_f32_bf16_dpp v164, v10, v74 row_newbcast:1 row_mask:0xf bank_mask:0xf
    v_dot2c_f32_bf16_dpp v165, v18, v74 row_newbcast:1 row_mask:0xf bank_mask:0xf
    v_dot2c_f32_bf16_dpp v166, v10, v75 row_newbcast:1 row_mask:0xf bank_mask:0xf
    v_dot2c_f32_bf16_dpp v167, v18, v75 row_newbcast:1 row_mask:0xf bank_mask:0xf
    buffer_load_dwordx4 v[72:75], v1, s[60:63], s86 offen offset:2048
    s_waitcnt vmcnt(31)
    v_dot2c_f32_bf16_dpp v160, v11, v76 row_newbcast:1 row_mask:0xf bank_mask:0xf
    v_dot2c_f32_bf16_dpp v161, v19, v76 row_newbcast:1 row_mask:0xf bank_mask:0xf
    v_dot2c_f32_bf16_dpp v162, v11, v77 row_newbcast:1 row_mask:0xf bank_mask:0xf
    v_dot2c_f32_bf16_dpp v163, v19, v77 row_newbcast:1 row_mask:0xf bank_mask:0xf
    v_dot2c_f32_bf16_dpp v164, v11, v78 row_newbcast:1 row_mask:0xf bank_mask:0xf
    v_dot2c_f32_bf16_dpp v165, v19, v78 row_newbcast:1 row_mask:0xf bank_mask:0xf
    v_dot2c_f32_bf16_dpp v166, v11, v79 row_newbcast:1 row_mask:0xf bank_mask:0xf
    v_dot2c_f32_bf16_dpp v167, v19, v79 row_newbcast:1 row_mask:0xf bank_mask:0xf
    buffer_load_dwordx4 v[76:79], v1, s[60:63], s86 offen offset:3072
    s_waitcnt vmcnt(31)
    v_dot2c_f32_bf16_dpp v160, v12, v80 row_newbcast:1 row_mask:0xf bank_mask:0xf
    v_dot2c_f32_bf16_dpp v161, v20, v80 row_newbcast:1 row_mask:0xf bank_mask:0xf
    v_dot2c_f32_bf16_dpp v162, v12, v81 row_newbcast:1 row_mask:0xf bank_mask:0xf
    v_dot2c_f32_bf16_dpp v163, v20, v81 row_newbcast:1 row_mask:0xf bank_mask:0xf
    v_dot2c_f32_bf16_dpp v164, v12, v82 row_newbcast:1 row_mask:0xf bank_mask:0xf
    v_dot2c_f32_bf16_dpp v165, v20, v82 row_newbcast:1 row_mask:0xf bank_mask:0xf
    v_dot2c_f32_bf16_dpp v166, v12, v83 row_newbcast:1 row_mask:0xf bank_mask:0xf
    v_dot2c_f32_bf16_dpp v167, v20, v83 row_newbcast:1 row_mask:0xf bank_mask:0xf
    buffer_load_dwordx4 v[80:83], v1, s[60:63], s87 offen offset:0
    s_waitcnt vmcnt(31)
    v_dot2c_f32_bf16_dpp v160, v13, v84 row_newbcast:1 row_mask:0xf bank_mask:0xf
    v_dot2c_f32_bf16_dpp v161, v21, v84 row_newbcast:1 row_mask:0xf bank_mask:0xf
    v_dot2c_f32_bf16_dpp v162, v13, v85 row_newbcast:1 row_mask:0xf bank_mask:0xf
    v_dot2c_f32_bf16_dpp v163, v21, v85 row_newbcast:1 row_mask:0xf bank_mask:0xf
    v_dot2c_f32_bf16_dpp v164, v13, v86 row_newbcast:1 row_mask:0xf bank_mask:0xf
    v_dot2c_f32_bf16_dpp v165, v21, v86 row_newbcast:1 row_mask:0xf bank_mask:0xf
    v_dot2c_f32_bf16_dpp v166, v13, v87 row_newbcast:1 row_mask:0xf bank_mask:0xf
    v_dot2c_f32_bf16_dpp v167, v21, v87 row_newbcast:1 row_mask:0xf bank_mask:0xf
    buffer_load_dwordx4 v[84:87], v1, s[60:63], s87 offen offset:1024
    s_waitcnt vmcnt(31)
    v_dot2c_f32_bf16_dpp v160, v14, v88 row_newbcast:1 row_mask:0xf bank_mask:0xf
    v_dot2c_f32_bf16_dpp v161, v22, v88 row_newbcast:1 row_mask:0xf bank_mask:0xf
    v_dot2c_f32_bf16_dpp v162, v14, v89 row_newbcast:1 row_mask:0xf bank_mask:0xf
    v_dot2c_f32_bf16_dpp v163, v22, v89 row_newbcast:1 row_mask:0xf bank_mask:0xf
    v_dot2c_f32_bf16_dpp v164, v14, v90 row_newbcast:1 row_mask:0xf bank_mask:0xf
    v_dot2c_f32_bf16_dpp v165, v22, v90 row_newbcast:1 row_mask:0xf bank_mask:0xf
    v_dot2c_f32_bf16_dpp v166, v14, v91 row_newbcast:1 row_mask:0xf bank_mask:0xf
    v_dot2c_f32_bf16_dpp v167, v22, v91 row_newbcast:1 row_mask:0xf bank_mask:0xf
    buffer_load_dwordx4 v[88:91], v1, s[60:63], s87 offen offset:2048
    s_waitcnt vmcnt(31)
    v_dot2c_f32_bf16_dpp v160, v15, v92 row_newbcast:1 row_mask:0xf bank_mask:0xf
    v_dot2c_f32_bf16_dpp v161, v23, v92 row_newbcast:1 row_mask:0xf bank_mask:0xf
    v_dot2c_f32_bf16_dpp v162, v15, v93 row_newbcast:1 row_mask:0xf bank_mask:0xf
    v_dot2c_f32_bf16_dpp v163, v23, v93 row_newbcast:1 row_mask:0xf bank_mask:0xf
    v_dot2c_f32_bf16_dpp v164, v15, v94 row_newbcast:1 row_mask:0xf bank_mask:0xf
    v_dot2c_f32_bf16_dpp v165, v23, v94 row_newbcast:1 row_mask:0xf bank_mask:0xf
    v_dot2c_f32_bf16_dpp v166, v15, v95 row_newbcast:1 row_mask:0xf bank_mask:0xf
    v_dot2c_f32_bf16_dpp v167, v23, v95 row_newbcast:1 row_mask:0xf bank_mask:0xf
    buffer_load_dwordx4 v[92:95], v1, s[60:63], s87 offen offset:3072
    s_add_u32 s84, s84, 16384
    s_add_u32 s85, s85, 16384
    s_add_u32 s86, s86, 16384
    s_add_u32 s87, s87, 16384
    s_waitcnt vmcnt(31)
    v_dot2c_f32_bf16_dpp v160, v8, v96 row_newbcast:2 row_mask:0xf bank_mask:0xf
    v_dot2c_f32_bf16_dpp v161, v16, v96 row_newbcast:2 row_mask:0xf bank_mask:0xf
    v_dot2c_f32_bf16_dpp v162, v8, v97 row_newbcast:2 row_mask:0xf bank_mask:0xf
    v_dot2c_f32_bf16_dpp v163, v16, v97 row_newbcast:2 row_mask:0xf bank_mask:0xf
    v_dot2c_f32_bf16_dpp v164, v8, v98 row_newbcast:2 row_mask:0xf bank_mask:0xf
    v_dot2c_f32_bf16_dpp v165, v16, v98 row_newbcast:2 row_mask:0xf bank_mask:0xf
    v_dot2c_f32_bf16_dpp v166, v8, v99 row_newbcast:2 row_mask:0xf bank_mask:0xf
    v_dot2c_f32_bf16_dpp v167, v16, v99 row_newbcast:2 row_mask:0xf bank_mask:0xf
    buffer_load_dwordx4 v[96:99], v1, s[60:63], s84 offen offset:0
    s_waitcnt vmcnt(31)
    v_dot2c_f32_bf16_dpp v160, v9, v100 row_newbcast:2 row_mask:0xf bank_mask:0xf
    v_dot2c_f32_bf16_dpp v161, v17, v100 row_newbcast:2 row_mask:0xf bank_mask:0xf
    v_dot2c_f32_bf16_dpp v162, v9, v101 row_newbcast:2 row_mask:0xf bank_mask:0xf
    v_dot2c_f32_bf16_dpp v163, v17, v101 row_newbcast:2 row_mask:0xf bank_mask:0xf
    v_dot2c_f32_bf16_dpp v164, v9, v102 row_newbcast:2 row_mask:0xf bank_mask:0xf
    v_dot2c_f32_bf16_dpp v165, v17, v102 row_newbcast:2 row_mask:0xf bank_mask:0xf
    v_dot2c_f32_bf16_dpp v166, v9, v103 row_newbcast:2 row_mask:0xf bank_mask:0xf
    v_dot2c_f32_bf16_dpp v167, v17, v103 row_newbcast:2 row_mask:0xf bank_mask:0xf
    buffer_load_dwordx4 v[100:103], v1, s[60:63], s84 offen offset:1024
    s_waitcnt vmcnt(31)
    v_dot2c_f32_bf16_dpp v160, v10, v104 row_newbcast:2 row_mask:0xf bank_mask:0xf
    v_dot2c_f32_bf16_dpp v161, v18, v104 row_newbcast:2 row_mask:0xf bank_mask:0xf
    v_dot2c_f32_bf16_dpp v162, v10, v105 row_newbcast:2 row_mask:0xf bank_mask:0xf
    v_dot2c_f32_bf16_dpp v163, v18, v105 row_newbcast:2 row_mask:0xf bank_mask:0xf
    v_dot2c_f32_bf16_dpp v164, v10, v106 row_newbcast:2 row_mask:0xf bank_mask:0xf
    v_dot2c_f32_bf16_dpp v165, v18, v106 row_newbcast:2 row_mask:0xf bank_mask:0xf
    v_dot2c_f32_bf16_dpp v166, v10, v107 row_newbcast:2 row_mask:0xf bank_mask:0xf
    v_dot2c_f32_bf16_dpp v167, v18, v107 row_newbcast:2 row_mask:0xf bank_mask:0xf
    buffer_load_dwordx4 v[104:107], v1, s[60:63], s84 offen offset:2048
    s_waitcnt vmcnt(31)
    v_dot2c_f32_bf16_dpp v160, v11, v108 row_newbcast:2 row_mask:0xf bank_mask:0xf
    v_dot2c_f32_bf16_dpp v161, v19, v108 row_newbcast:2 row_mask:0xf bank_mask:0xf
    v_dot2c_f32_bf16_dpp v162, v11, v109 row_newbcast:2 row_mask:0xf bank_mask:0xf
    v_dot2c_f32_bf16_dpp v163, v19, v109 row_newbcast:2 row_mask:0xf bank_mask:0xf
    v_dot2c_f32_bf16_dpp v164, v11, v110 row_newbcast:2 row_mask:0xf bank_mask:0xf
    v_dot2c_f32_bf16_dpp v165, v19, v110 row_newbcast:2 row_mask:0xf bank_mask:0xf
    v_dot2c_f32_bf16_dpp v166, v11, v111 row_newbcast:2 row_mask:0xf bank_mask:0xf
    v_dot2c_f32_bf16_dpp v167, v19, v111 row_newbcast:2 row_mask:0xf bank_mask:0xf
    buffer_load_dwordx4 v[108:111], v1, s[60:63], s84 offen offset:3072
    s_waitcnt vmcnt(31)
    v_dot2c_f32_bf16_dpp v160, v12, v112 row_newbcast:2 row_mask:0xf bank_mask:0xf
    v_dot2c_f32_bf16_dpp v161, v20, v112 row_newbcast:2 row_mask:0xf bank_mask:0xf
    v_dot2c_f32_bf16_dpp v162, v12, v113 row_newbcast:2 row_mask:0xf bank_mask:0xf
    v_dot2c_f32_bf16_dpp v163, v20, v113 row_newbcast:2 row_mask:0xf bank_mask:0xf
    v_dot2c_f32_bf16_dpp v164, v12, v114 row_newbcast:2 row_mask:0xf bank_mask:0xf
    v_dot2c_f32_bf16_dpp v165, v20, v114 row_newbcast:2 row_mask:0xf bank_mask:0xf
    v_dot2c_f32_bf16_dpp v166, v12, v115 row_newbcast:2 row_mask:0xf bank_mask:0xf
    v_dot2c_f32_bf16_dpp v167, v20, v115 row_newbcast:2 row_mask:0xf bank_mask:0xf
    buffer_load_dwordx4 v[112:115], v1, s[60:63], s85 offen offset:0
    s_waitcnt vmcnt(31)
    v_dot2c_f32_bf16_dpp v160, v13, v116 row_newbcast:2 row_mask:0xf bank_mask:0xf
    v_dot2c_f32_bf16_dpp v161, v21, v116 row_newbcast:2 row_mask:0xf bank_mask:0xf
    v_dot2c_f32_bf16_dpp v162, v13, v117 row_newbcast:2 row_mask:0xf bank_mask:0xf
    v_dot2c_f32_bf16_dpp v163, v21, v117 row_newbcast:2 row_mask:0xf bank_mask:0xf
    v_dot2c_f32_bf16_dpp v164, v13, v118 row_newbcast:2 row_mask:0xf bank_mask:0xf
    v_dot2c_f32_bf16_dpp v165, v21, v118 row_newbcast:2 row_mask:0xf bank_mask:0xf
    v_dot2c_f32_bf16_dpp v166, v13, v119 row_newbcast:2 row_mask:0xf bank_mask:0xf
    v_dot2c_f32_bf16_dpp v167, v21, v119 row_newbcast:2 row_mask:0xf bank_mask:0xf
    buffer_load_dwordx4 v[116:119], v1, s[60:63], s85 offen offset:1024
    s_waitcnt vmcnt(31)
    v_dot2c_f32_bf16_dpp v160, v14, v120 row_newbcast:2 row_mask:0xf bank_mask:0xf
    v_dot2c_f32_bf16_dpp v161, v22, v120 row_newbcast:2 row_mask:0xf bank_mask:0xf
    v_dot2c_f32_bf16_dpp v162, v14, v121 row_newbcast:2 row_mask:0xf bank_mask:0xf
    v_dot2c_f32_bf16_dpp v163, v22, v121 row_newbcast:2 row_mask:0xf bank_mask:0xf
    v_dot2c_f32_bf16_dpp v164, v14, v122 row_newbcast:2 row_mask:0xf bank_mask:0xf
    v_dot2c_f32_bf16_dpp v165, v22, v122 row_newbcast:2 row_mask:0xf bank_mask:0xf
    v_dot2c_f32_bf16_dpp v166, v14, v123 row_newbcast:2 row_mask:0xf bank_mask:0xf
    v_dot2c_f32_bf16_dpp v167, v22, v123 row_newbcast:2 row_mask:0xf bank_mask:0xf
    buffer_load_dwordx4 v[120:123], v1, s[60:63], s85 offen offset:2048
    s_waitcnt vmcnt(31)
    v_dot2c_f32_bf16_dpp v160, v15, v124 row_newbcast:2 row_mask:0xf bank_mask:0xf
    v_dot2c_f32_bf16_dpp v161, v23, v124 row_newbcast:2 row_mask:0xf bank_mask:0xf
    v_dot2c_f32_bf16_dpp v162, v15, v125 row_newbcast:2 row_mask:0xf bank_mask:0xf
    v_dot2c_f32_bf16_dpp v163, v23, v125 row_newbcast:2 row_mask:0xf bank_mask:0xf
    v_dot2c_f32_bf16_dpp v164, v15, v126 row_newbcast:2 row_mask:0xf bank_mask:0xf
    v_dot2c_f32_bf16_dpp v165, v23, v126 row_newbcast:2 row_mask:0xf bank_mask:0xf
    v_dot2c_f32_bf16_dpp v166, v15, v127 row_newbcast:2 row_mask:0xf bank_mask:0xf
    v_dot2c_f32_bf16_dpp v167, v23, v127 row_newbcast:2 row_mask:0xf bank_mask:0xf
    buffer_load_dwordx4 v[124:127], v1, s[60:63], s85 offen offset:3072
    s_waitcnt vmcnt(31)
    v_dot2c_f32_bf16_dpp v160, v8, v128 row_newbcast:3 row_mask:0xf bank_mask:0xf
    v_dot2c_f32_bf16_dpp v161, v16, v128 row_newbcast:3 row_mask:0xf bank_mask:0xf
    v_dot2c_f32_bf16_dpp v162, v8, v129 row_newbcast:3 row_mask:0xf bank_mask:0xf
    v_dot2c_f32_bf16_dpp v163, v16, v129 row_newbcast:3 row_mask:0xf bank_mask:0xf
    v_dot2c_f32_bf16_dpp v164, v8, v130 row_newbcast:3 row_mask:0xf bank_mask:0xf
    v_dot2c_f32_bf16_dpp v165, v16, v130 row_newbcast:3 row_mask:0xf bank_mask:0xf
    v_dot2c_f32_bf16_dpp v166, v8, v131 row_newbcast:3 row_mask:0xf bank_mask:0xf
    v_dot2c_f32_bf16_dpp v167, v16, v131 row_newbcast:3 row_mask:0xf bank_mask:0xf
    buffer_load_dwordx4 v[128:131], v1, s[60:63], s86 offen offset:0
    s_waitcnt vmcnt(31)
    v_dot2c_f32_bf16_dpp v160, v9, v132 row_newbcast:3 row_mask:0xf bank_mask:0xf
    v_dot2c_f32_bf16_dpp v161, v17, v132 row_newbcast:3 row_mask:0xf bank_mask:0xf
    v_dot2c_f32_bf16_dpp v162, v9, v133 row_newbcast:3 row_mask:0xf bank_mask:0xf
    v_dot2c_f32_bf16_dpp v163, v17, v133 row_newbcast:3 row_mask:0xf bank_mask:0xf
    v_dot2c_f32_bf16_dpp v164, v9, v134 row_newbcast:3 row_mask:0xf bank_mask:0xf
    v_dot2c_f32_bf16_dpp v165, v17, v134 row_newbcast:3 row_mask:0xf bank_mask:0xf
    v_dot2c_f32_bf16_dpp v166, v9, v135 row_newbcast:3 row_mask:0xf bank_mask:0xf
    v_dot2c_f32_bf16_dpp v167, v17, v135 row_newbcast:3 row_mask:0xf bank_mask:0xf
    buffer_load_dwordx4 v[132:135], v1, s[60:63], s86 offen offset:1024
    s_waitcnt vmcnt(31)
    v_dot2c_f32_bf16_dpp v160, v10, v136 row_newbcast:3 row_mask:0xf bank_mask:0xf
    v_dot2c_f32_bf16_dpp v161, v18, v136 row_newbcast:3 row_mask:0xf bank_mask:0xf
    v_dot2c_f32_bf16_dpp v162, v10, v137 row_newbcast:3 row_mask:0xf bank_mask:0xf
    v_dot2c_f32_bf16_dpp v163, v18, v137 row_newbcast:3 row_mask:0xf bank_mask:0xf
    v_dot2c_f32_bf16_dpp v164, v10, v138 row_newbcast:3 row_mask:0xf bank_mask:0xf
    v_dot2c_f32_bf16_dpp v165, v18, v138 row_newbcast:3 row_mask:0xf bank_mask:0xf
    v_dot2c_f32_bf16_dpp v166, v10, v139 row_newbcast:3 row_mask:0xf bank_mask:0xf
    v_dot2c_f32_bf16_dpp v167, v18, v139 row_newbcast:3 row_mask:0xf bank_mask:0xf
    buffer_load_dwordx4 v[136:139], v1, s[60:63], s86 offen offset:2048
    s_waitcnt vmcnt(31)
    v_dot2c_f32_bf16_dpp v160, v11, v140 row_newbcast:3 row_mask:0xf bank_mask:0xf
    v_dot2c_f32_bf16_dpp v161, v19, v140 row_newbcast:3 row_mask:0xf bank_mask:0xf
    v_dot2c_f32_bf16_dpp v162, v11, v141 row_newbcast:3 row_mask:0xf bank_mask:0xf
    v_dot2c_f32_bf16_dpp v163, v19, v141 row_newbcast:3 row_mask:0xf bank_mask:0xf
    v_dot2c_f32_bf16_dpp v164, v11, v142 row_newbcast:3 row_mask:0xf bank_mask:0xf
    v_dot2c_f32_bf16_dpp v165, v19, v142 row_newbcast:3 row_mask:0xf bank_mask:0xf
    v_dot2c_f32_bf16_dpp v166, v11, v143 row_newbcast:3 row_mask:0xf bank_mask:0xf
    v_dot2c_f32_bf16_dpp v167, v19, v143 row_newbcast:3 row_mask:0xf bank_mask:0xf
    buffer_load_dwordx4 v[140:143], v1, s[60:63], s86 offen offset:3072
    s_waitcnt vmcnt(31)
    v_dot2c_f32_bf16_dpp v160, v12, v144 row_newbcast:3 row_mask:0xf bank_mask:0xf
    v_dot2c_f32_bf16_dpp v161, v20, v144 row_newbcast:3 row_mask:0xf bank_mask:0xf
    v_dot2c_f32_bf16_dpp v162, v12, v145 row_newbcast:3 row_mask:0xf bank_mask:0xf
    v_dot2c_f32_bf16_dpp v163, v20, v145 row_newbcast:3 row_mask:0xf bank_mask:0xf
    v_dot2c_f32_bf16_dpp v164, v12, v146 row_newbcast:3 row_mask:0xf bank_mask:0xf
    v_dot2c_f32_bf16_dpp v165, v20, v146 row_newbcast:3 row_mask:0xf bank_mask:0xf
    v_dot2c_f32_bf16_dpp v166, v12, v147 row_newbcast:3 row_mask:0xf bank_mask:0xf
    v_dot2c_f32_bf16_dpp v167, v20, v147 row_newbcast:3 row_mask:0xf bank_mask:0xf
    buffer_load_dwordx4 v[144:147], v1, s[60:63], s87 offen offset:0
    s_waitcnt vmcnt(31)
    v_dot2c_f32_bf16_dpp v160, v13, v148 row_newbcast:3 row_mask:0xf bank_mask:0xf
    v_dot2c_f32_bf16_dpp v161, v21, v148 row_newbcast:3 row_mask:0xf bank_mask:0xf
    v_dot2c_f32_bf16_dpp v162, v13, v149 row_newbcast:3 row_mask:0xf bank_mask:0xf
    v_dot2c_f32_bf16_dpp v163, v21, v149 row_newbcast:3 row_mask:0xf bank_mask:0xf
    v_dot2c_f32_bf16_dpp v164, v13, v150 row_newbcast:3 row_mask:0xf bank_mask:0xf
    v_dot2c_f32_bf16_dpp v165, v21, v150 row_newbcast:3 row_mask:0xf bank_mask:0xf
    v_dot2c_f32_bf16_dpp v166, v13, v151 row_newbcast:3 row_mask:0xf bank_mask:0xf
    v_dot2c_f32_bf16_dpp v167, v21, v151 row_newbcast:3 row_mask:0xf bank_mask:0xf
    buffer_load_dwordx4 v[148:151], v1, s[60:63], s87 offen offset:1024
    s_waitcnt vmcnt(31)
    v_dot2c_f32_bf16_dpp v160, v14, v152 row_newbcast:3 row_mask:0xf bank_mask:0xf
    v_dot2c_f32_bf16_dpp v161, v22, v152 row_newbcast:3 row_mask:0xf bank_mask:0xf
    v_dot2c_f32_bf16_dpp v162, v14, v153 row_newbcast:3 row_mask:0xf bank_mask:0xf
    v_dot2c_f32_bf16_dpp v163, v22, v153 row_newbcast:3 row_mask:0xf bank_mask:0xf
    v_dot2c_f32_bf16_dpp v164, v14, v154 row_newbcast:3 row_mask:0xf bank_mask:0xf
    v_dot2c_f32_bf16_dpp v165, v22, v154 row_newbcast:3 row_mask:0xf bank_mask:0xf
    v_dot2c_f32_bf16_dpp v166, v14, v155 row_newbcast:3 row_mask:0xf bank_mask:0xf
    v_dot2c_f32_bf16_dpp v167, v22, v155 row_newbcast:3 row_mask:0xf bank_mask:0xf
    buffer_load_dwordx4 v[152:155], v1, s[60:63], s87 offen offset:2048
    s_waitcnt vmcnt(31)
    v_dot2c_f32_bf16_dpp v160, v15, v156 row_newbcast:3 row_mask:0xf bank_mask:0xf
    v_dot2c_f32_bf16_dpp v161, v23, v156 row_newbcast:3 row_mask:0xf bank_mask:0xf
    v_dot2c_f32_bf16_dpp v162, v15, v157 row_newbcast:3 row_mask:0xf bank_mask:0xf
    v_dot2c_f32_bf16_dpp v163, v23, v157 row_newbcast:3 row_mask:0xf bank_mask:0xf
    v_dot2c_f32_bf16_dpp v164, v15, v158 row_newbcast:3 row_mask:0xf bank_mask:0xf
    v_dot2c_f32_bf16_dpp v165, v23, v158 row_newbcast:3 row_mask:0xf bank_mask:0xf
    v_dot2c_f32_bf16_dpp v166, v15, v159 row_newbcast:3 row_mask:0xf bank_mask:0xf
    v_dot2c_f32_bf16_dpp v167, v23, v159 row_newbcast:3 row_mask:0xf bank_mask:0xf
    buffer_load_dwordx4 v[156:159], v1, s[60:63], s87 offen offset:3072
    s_waitcnt vmcnt(31)
    v_dot2c_f32_bf16_dpp v160, v8, v32 row_newbcast:4 row_mask:0xf bank_mask:0xf
    v_dot2c_f32_bf16_dpp v161, v16, v32 row_newbcast:4 row_mask:0xf bank_mask:0xf
    v_dot2c_f32_bf16_dpp v162, v8, v33 row_newbcast:4 row_mask:0xf bank_mask:0xf
    v_dot2c_f32_bf16_dpp v163, v16, v33 row_newbcast:4 row_mask:0xf bank_mask:0xf
    v_dot2c_f32_bf16_dpp v164, v8, v34 row_newbcast:4 row_mask:0xf bank_mask:0xf
    v_dot2c_f32_bf16_dpp v165, v16, v34 row_newbcast:4 row_mask:0xf bank_mask:0xf
    v_dot2c_f32_bf16_dpp v166, v8, v35 row_newbcast:4 row_mask:0xf bank_mask:0xf
    v_dot2c_f32_bf16_dpp v167, v16, v35 row_newbcast:4 row_mask:0xf bank_mask:0xf
    s_waitcnt vmcnt(30)
    v_dot2c_f32_bf16_dpp v160, v9, v36 row_newbcast:4 row_mask:0xf bank_mask:0xf
    v_dot2c_f32_bf16_dpp v161, v17, v36 row_newbcast:4 row_mask:0xf bank_mask:0xf
    v_dot2c_f32_bf16_dpp v162, v9, v37 row_newbcast:4 row_mask:0xf bank_mask:0xf
    v_dot2c_f32_bf16_dpp v163, v17, v37 row_newbcast:4 row_mask:0xf bank_mask:0xf
    v_dot2c_f32_bf16_dpp v164, v9, v38 row_newbcast:4 row_mask:0xf bank_mask:0xf
    v_dot2c_f32_bf16_dpp v165, v17, v38 row_newbcast:4 row_mask:0xf bank_mask:0xf
    v_dot2c_f32_bf16_dpp v166, v9, v39 row_newbcast:4 row_mask:0xf bank_mask:0xf
    v_dot2c_f32_bf16_dpp v167, v17, v39 row_newbcast:4 row_mask:0xf bank_mask:0xf
    s_waitcnt vmcnt(29)
    v_dot2c_f32_bf16_dpp v160, v10, v40 row_newbcast:4 row_mask:0xf bank_mask:0xf
    v_dot2c_f32_bf16_dpp v161, v18, v40 row_newbcast:4 row_mask:0xf bank_mask:0xf
    v_dot2c_f32_bf16_dpp v162, v10, v41 row_newbcast:4 row_mask:0xf bank_mask:0xf
    v_dot2c_f32_bf16_dpp v163, v18, v41 row_newbcast:4 row_mask:0xf bank_mask:0xf
    v_dot2c_f32_bf16_dpp v164, v10, v42 row_newbcast:4 row_mask:0xf bank_mask:0xf
    v_dot2c_f32_bf16_dpp v165, v18, v42 row_newbcast:4 row_mask:0xf bank_mask:0xf
    v_dot2c_f32_bf16_dpp v166, v10, v43 row_newbcast:4 row_mask:0xf bank_mask:0xf
    v_dot2c_f32_bf16_dpp v167, v18, v43 row_newbcast:4 row_mask:0xf bank_mask:0xf
    s_waitcnt vmcnt(28)
    v_dot2c_f32_bf16_dpp v160, v11, v44 row_newbcast:4 row_mask:0xf bank_mask:0xf
    v_dot2c_f32_bf16_dpp v161, v19, v44 row_newbcast:4 row_mask:0xf bank_mask:0xf
    v_dot2c_f32_bf16_dpp v162, v11, v45 row_newbcast:4 row_mask:0xf bank_mask:0xf
    v_dot2c_f32_bf16_dpp v163, v19, v45 row_newbcast:4 row_mask:0xf bank_mask:0xf
    v_dot2c_f32_bf16_dpp v164, v11, v46 row_newbcast:4 row_mask:0xf bank_mask:0xf
    v_dot2c_f32_bf16_dpp v165, v19, v46 row_newbcast:4 row_mask:0xf bank_mask:0xf
    v_dot2c_f32_bf16_dpp v166, v11, v47 row_newbcast:4 row_mask:0xf bank_mask:0xf
    v_dot2c_f32_bf16_dpp v167, v19, v47 row_newbcast:4 row_mask:0xf bank_mask:0xf
    s_waitcnt vmcnt(27)
    v_dot2c_f32_bf16_dpp v160, v12, v48 row_newbcast:4 row_mask:0xf bank_mask:0xf
    v_dot2c_f32_bf16_dpp v161, v20, v48 row_newbcast:4 row_mask:0xf bank_mask:0xf
    v_dot2c_f32_bf16_dpp v162, v12, v49 row_newbcast:4 row_mask:0xf bank_mask:0xf
    v_dot2c_f32_bf16_dpp v163, v20, v49 row_newbcast:4 row_mask:0xf bank_mask:0xf
    v_dot2c_f32_bf16_dpp v164, v12, v50 row_newbcast:4 row_mask:0xf bank_mask:0xf
    v_dot2c_f32_bf16_dpp v165, v20, v50 row_newbcast:4 row_mask:0xf bank_mask:0xf
    v_dot2c_f32_bf16_dpp v166, v12, v51 row_newbcast:4 row_mask:0xf bank_mask:0xf
    v_dot2c_f32_bf16_dpp v167, v20, v51 row_newbcast:4 row_mask:0xf bank_mask:0xf
    s_waitcnt vmcnt(26)
    v_dot2c_f32_bf16_dpp v160, v13, v52 row_newbcast:4 row_mask:0xf bank_mask:0xf
    v_dot2c_f32_bf16_dpp v161, v21, v52 row_newbcast:4 row_mask:0xf bank_mask:0xf
    v_dot2c_f32_bf16_dpp v162, v13, v53 row_newbcast:4 row_mask:0xf bank_mask:0xf
    v_dot2c_f32_bf16_dpp v163, v21, v53 row_newbcast:4 row_mask:0xf bank_mask:0xf
    v_dot2c_f32_bf16_dpp v164, v13, v54 row_newbcast:4 row_mask:0xf bank_mask:0xf
    v_dot2c_f32_bf16_dpp v165, v21, v54 row_newbcast:4 row_mask:0xf bank_mask:0xf
    v_dot2c_f32_bf16_dpp v166, v13, v55 row_newbcast:4 row_mask:0xf bank_mask:0xf
    v_dot2c_f32_bf16_dpp v167, v21, v55 row_newbcast:4 row_mask:0xf bank_mask:0xf
    s_waitcnt vmcnt(25)
    v_dot2c_f32_bf16_dpp v160, v14, v56 row_newbcast:4 row_mask:0xf bank_mask:0xf
    v_dot2c_f32_bf16_dpp v161, v22, v56 row_newbcast:4 row_mask:0xf bank_mask:0xf
    v_dot2c_f32_bf16_dpp v162, v14, v57 row_newbcast:4 row_mask:0xf bank_mask:0xf
    v_dot2c_f32_bf16_dpp v163, v22, v57 row_newbcast:4 row_mask:0xf bank_mask:0xf
    v_dot2c_f32_bf16_dpp v164, v14, v58 row_newbcast:4 row_mask:0xf bank_mask:0xf
    v_dot2c_f32_bf16_dpp v165, v22, v58 row_newbcast:4 row_mask:0xf bank_mask:0xf
    v_dot2c_f32_bf16_dpp v166, v14, v59 row_newbcast:4 row_mask:0xf bank_mask:0xf
    v_dot2c_f32_bf16_dpp v167, v22, v59 row_newbcast:4 row_mask:0xf bank_mask:0xf
    s_waitcnt vmcnt(24)
    v_dot2c_f32_bf16_dpp v160, v15, v60 row_newbcast:4 row_mask:0xf bank_mask:0xf
    v_dot2c_f32_bf16_dpp v161, v23, v60 row_newbcast:4 row_mask:0xf bank_mask:0xf
    v_dot2c_f32_bf16_dpp v162, v15, v61 row_newbcast:4 row_mask:0xf bank_mask:0xf
    v_dot2c_f32_bf16_dpp v163, v23, v61 row_newbcast:4 row_mask:0xf bank_mask:0xf
    v_dot2c_f32_bf16_dpp v164, v15, v62 row_newbcast:4 row_mask:0xf bank_mask:0xf
    v_dot2c_f32_bf16_dpp v165, v23, v62 row_newbcast:4 row_mask:0xf bank_mask:0xf
    v_dot2c_f32_bf16_dpp v166, v15, v63 row_newbcast:4 row_mask:0xf bank_mask:0xf
    v_dot2c_f32_bf16_dpp v167, v23, v63 row_newbcast:4 row_mask:0xf bank_mask:0xf
    s_waitcnt vmcnt(23)
    v_dot2c_f32_bf16_dpp v160, v8, v64 row_newbcast:5 row_mask:0xf bank_mask:0xf
    v_dot2c_f32_bf16_dpp v161, v16, v64 row_newbcast:5 row_mask:0xf bank_mask:0xf
    v_dot2c_f32_bf16_dpp v162, v8, v65 row_newbcast:5 row_mask:0xf bank_mask:0xf
    v_dot2c_f32_bf16_dpp v163, v16, v65 row_newbcast:5 row_mask:0xf bank_mask:0xf
    v_dot2c_f32_bf16_dpp v164, v8, v66 row_newbcast:5 row_mask:0xf bank_mask:0xf
    v_dot2c_f32_bf16_dpp v165, v16, v66 row_newbcast:5 row_mask:0xf bank_mask:0xf
    v_dot2c_f32_bf16_dpp v166, v8, v67 row_newbcast:5 row_mask:0xf bank_mask:0xf
    v_dot2c_f32_bf16_dpp v167, v16, v67 row_newbcast:5 row_mask:0xf bank_mask:0xf
    s_waitcnt vmcnt(22)
    v_dot2c_f32_bf16_dpp v160, v9, v68 row_newbcast:5 row_mask:0xf bank_mask:0xf
    v_dot2c_f32_bf16_dpp v161, v17, v68 row_newbcast:5 row_mask:0xf bank_mask:0xf
    v_dot2c_f32_bf16_dpp v162, v9, v69 row_newbcast:5 row_mask:0xf bank_mask:0xf
    v_dot2c_f32_bf16_dpp v163, v17, v69 row_newbcast:5 row_mask:0xf bank_mask:0xf
    v_dot2c_f32_bf16_dpp v164, v9, v70 row_newbcast:5 row_mask:0xf bank_mask:0xf
    v_dot2c_f32_bf16_dpp v165, v17, v70 row_newbcast:5 row_mask:0xf bank_mask:0xf
    v_dot2c_f32_bf16_dpp v166, v9, v71 row_newbcast:5 row_mask:0xf bank_mask:0xf
    v_dot2c_f32_bf16_dpp v167, v17, v71 row_newbcast:5 row_mask:0xf bank_mask:0xf
    s_waitcnt vmcnt(21)
    v_dot2c_f32_bf16_dpp v160, v10, v72 row_newbcast:5 row_mask:0xf bank_mask:0xf
    v_dot2c_f32_bf16_dpp v161, v18, v72 row_newbcast:5 row_mask:0xf bank_mask:0xf
    v_dot2c_f32_bf16_dpp v162, v10, v73 row_newbcast:5 row_mask:0xf bank_mask:0xf
    v_dot2c_f32_bf16_dpp v163, v18, v73 row_newbcast:5 row_mask:0xf bank_mask:0xf
    v_dot2c_f32_bf16_dpp v164, v10, v74 row_newbcast:5 row_mask:0xf bank_mask:0xf
    v_dot2c_f32_bf16_dpp v165, v18, v74 row_newbcast:5 row_mask:0xf bank_mask:0xf
    v_dot2c_f32_bf16_dpp v166, v10, v75 row_newbcast:5 row_mask:0xf bank_mask:0xf
    v_dot2c_f32_bf16_dpp v167, v18, v75 row_newbcast:5 row_mask:0xf bank_mask:0xf
    s_waitcnt vmcnt(20)
    v_dot2c_f32_bf16_dpp v160, v11, v76 row_newbcast:5 row_mask:0xf bank_mask:0xf
    v_dot2c_f32_bf16_dpp v161, v19, v76 row_newbcast:5 row_mask:0xf bank_mask:0xf
    v_dot2c_f32_bf16_dpp v162, v11, v77 row_newbcast:5 row_mask:0xf bank_mask:0xf
    v_dot2c_f32_bf16_dpp v163, v19, v77 row_newbcast:5 row_mask:0xf bank_mask:0xf
    v_dot2c_f32_bf16_dpp v164, v11, v78 row_newbcast:5 row_mask:0xf bank_mask:0xf
    v_dot2c_f32_bf16_dpp v165, v19, v78 row_newbcast:5 row_mask:0xf bank_mask:0xf
    v_dot2c_f32_bf16_dpp v166, v11, v79 row_newbcast:5 row_mask:0xf bank_mask:0xf
    v_dot2c_f32_bf16_dpp v167, v19, v79 row_newbcast:5 row_mask:0xf bank_mask:0xf
    s_waitcnt vmcnt(19)
    v_dot2c_f32_bf16_dpp v160, v12, v80 row_newbcast:5 row_mask:0xf bank_mask:0xf
    v_dot2c_f32_bf16_dpp v161, v20, v80 row_newbcast:5 row_mask:0xf bank_mask:0xf
    v_dot2c_f32_bf16_dpp v162, v12, v81 row_newbcast:5 row_mask:0xf bank_mask:0xf
    v_dot2c_f32_bf16_dpp v163, v20, v81 row_newbcast:5 row_mask:0xf bank_mask:0xf
    v_dot2c_f32_bf16_dpp v164, v12, v82 row_newbcast:5 row_mask:0xf bank_mask:0xf
    v_dot2c_f32_bf16_dpp v165, v20, v82 row_newbcast:5 row_mask:0xf bank_mask:0xf
    v_dot2c_f32_bf16_dpp v166, v12, v83 row_newbcast:5 row_mask:0xf bank_mask:0xf
    v_dot2c_f32_bf16_dpp v167, v20, v83 row_newbcast:5 row_mask:0xf bank_mask:0xf
    s_waitcnt vmcnt(18)
    v_dot2c_f32_bf16_dpp v160, v13, v84 row_newbcast:5 row_mask:0xf bank_mask:0xf
    v_dot2c_f32_bf16_dpp v161, v21, v84 row_newbcast:5 row_mask:0xf bank_mask:0xf
    v_dot2c_f32_bf16_dpp v162, v13, v85 row_newbcast:5 row_mask:0xf bank_mask:0xf
    v_dot2c_f32_bf16_dpp v163, v21, v85 row_newbcast:5 row_mask:0xf bank_mask:0xf
    v_dot2c_f32_bf16_dpp v164, v13, v86 row_newbcast:5 row_mask:0xf bank_mask:0xf
    v_dot2c_f32_bf16_dpp v165, v21, v86 row_newbcast:5 row_mask:0xf bank_mask:0xf
    v_dot2c_f32_bf16_dpp v166, v13, v87 row_newbcast:5 row_mask:0xf bank_mask:0xf
    v_dot2c_f32_bf16_dpp v167, v21, v87 row_newbcast:5 row_mask:0xf bank_mask:0xf
    s_waitcnt vmcnt(17)
    v_dot2c_f32_bf16_dpp v160, v14, v88 row_newbcast:5 row_mask:0xf bank_mask:0xf
    v_dot2c_f32_bf16_dpp v161, v22, v88 row_newbcast:5 row_mask:0xf bank_mask:0xf
    v_dot2c_f32_bf16_dpp v162, v14, v89 row_newbcast:5 row_mask:0xf bank_mask:0xf
    v_dot2c_f32_bf16_dpp v163, v22, v89 row_newbcast:5 row_mask:0xf bank_mask:0xf
    v_dot2c_f32_bf16_dpp v164, v14, v90 row_newbcast:5 row_mask:0xf bank_mask:0xf
    v_dot2c_f32_bf16_dpp v165, v22, v90 row_newbcast:5 row_mask:0xf bank_mask:0xf
    v_dot2c_f32_bf16_dpp v166, v14, v91 row_newbcast:5 row_mask:0xf bank_mask:0xf
    v_dot2c_f32_bf16_dpp v167, v22, v91 row_newbcast:5 row_mask:0xf bank_mask:0xf
    s_waitcnt vmcnt(16)
    v_dot2c_f32_bf16_dpp v160, v15, v92 row_newbcast:5 row_mask:0xf bank_mask:0xf
    v_dot2c_f32_bf16_dpp v161, v23, v92 row_newbcast:5 row_mask:0xf bank_mask:0xf
    v_dot2c_f32_bf16_dpp v162, v15, v93 row_newbcast:5 row_mask:0xf bank_mask:0xf
    v_dot2c_f32_bf16_dpp v163, v23, v93 row_newbcast:5 row_mask:0xf bank_mask:0xf
    v_dot2c_f32_bf16_dpp v164, v15, v94 row_newbcast:5 row_mask:0xf bank_mask:0xf
    v_dot2c_f32_bf16_dpp v165, v23, v94 row_newbcast:5 row_mask:0xf bank_mask:0xf
    v_dot2c_f32_bf16_dpp v166, v15, v95 row_newbcast:5 row_mask:0xf bank_mask:0xf
    v_dot2c_f32_bf16_dpp v167, v23, v95 row_newbcast:5 row_mask:0xf bank_mask:0xf
    s_waitcnt vmcnt(15)
    v_dot2c_f32_bf16_dpp v160, v8, v96 row_newbcast:6 row_mask:0xf bank_mask:0xf
    v_dot2c_f32_bf16_dpp v161, v16, v96 row_newbcast:6 row_mask:0xf bank_mask:0xf
    v_dot2c_f32_bf16_dpp v162, v8, v97 row_newbcast:6 row_mask:0xf bank_mask:0xf
    v_dot2c_f32_bf16_dpp v163, v16, v97 row_newbcast:6 row_mask:0xf bank_mask:0xf
    v_dot2c_f32_bf16_dpp v164, v8, v98 row_newbcast:6 row_mask:0xf bank_mask:0xf
    v_dot2c_f32_bf16_dpp v165, v16, v98 row_newbcast:6 row_mask:0xf bank_mask:0xf
    v_dot2c_f32_bf16_dpp v166, v8, v99 row_newbcast:6 row_mask:0xf bank_mask:0xf
    v_dot2c_f32_bf16_dpp v167, v16, v99 row_newbcast:6 row_mask:0xf bank_mask:0xf
    s_waitcnt vmcnt(14)
    v_dot2c_f32_bf16_dpp v160, v9, v100 row_newbcast:6 row_mask:0xf bank_mask:0xf
    v_dot2c_f32_bf16_dpp v161, v17, v100 row_newbcast:6 row_mask:0xf bank_mask:0xf
    v_dot2c_f32_bf16_dpp v162, v9, v101 row_newbcast:6 row_mask:0xf bank_mask:0xf
    v_dot2c_f32_bf16_dpp v163, v17, v101 row_newbcast:6 row_mask:0xf bank_mask:0xf
    v_dot2c_f32_bf16_dpp v164, v9, v102 row_newbcast:6 row_mask:0xf bank_mask:0xf
    v_dot2c_f32_bf16_dpp v165, v17, v102 row_newbcast:6 row_mask:0xf bank_mask:0xf
    v_dot2c_f32_bf16_dpp v166, v9, v103 row_newbcast:6 row_mask:0xf bank_mask:0xf
    v_dot2c_f32_bf16_dpp v167, v17, v103 row_newbcast:6 row_mask:0xf bank_mask:0xf
    s_waitcnt vmcnt(13)
    v_dot2c_f32_bf16_dpp v160, v10, v104 row_newbcast:6 row_mask:0xf bank_mask:0xf
    v_dot2c_f32_bf16_dpp v161, v18, v104 row_newbcast:6 row_mask:0xf bank_mask:0xf
    v_dot2c_f32_bf16_dpp v162, v10, v105 row_newbcast:6 row_mask:0xf bank_mask:0xf
    v_dot2c_f32_bf16_dpp v163, v18, v105 row_newbcast:6 row_mask:0xf bank_mask:0xf
    v_dot2c_f32_bf16_dpp v164, v10, v106 row_newbcast:6 row_mask:0xf bank_mask:0xf
    v_dot2c_f32_bf16_dpp v165, v18, v106 row_newbcast:6 row_mask:0xf bank_mask:0xf
    v_dot2c_f32_bf16_dpp v166, v10, v107 row_newbcast:6 row_mask:0xf bank_mask:0xf
    v_dot2c_f32_bf16_dpp v167, v18, v107 row_newbcast:6 row_mask:0xf bank_mask:0xf
    s_waitcnt vmcnt(12)
    v_dot2c_f32_bf16_dpp v160, v11, v108 row_newbcast:6 row_mask:0xf bank_mask:0xf
    v_dot2c_f32_bf16_dpp v161, v19, v108 row_newbcast:6 row_mask:0xf bank_mask:0xf
    v_dot2c_f32_bf16_dpp v162, v11, v109 row_newbcast:6 row_mask:0xf bank_mask:0xf
    v_dot2c_f32_bf16_dpp v163, v19, v109 row_newbcast:6 row_mask:0xf bank_mask:0xf
    v_dot2c_f32_bf16_dpp v164, v11, v110 row_newbcast:6 row_mask:0xf bank_mask:0xf
    v_dot2c_f32_bf16_dpp v165, v19, v110 row_newbcast:6 row_mask:0xf bank_mask:0xf
    v_dot2c_f32_bf16_dpp v166, v11, v111 row_newbcast:6 row_mask:0xf bank_mask:0xf
    v_dot2c_f32_bf16_dpp v167, v19, v111 row_newbcast:6 row_mask:0xf bank_mask:0xf
    s_waitcnt vmcnt(11)
    v_dot2c_f32_bf16_dpp v160, v12, v112 row_newbcast:6 row_mask:0xf bank_mask:0xf
    v_dot2c_f32_bf16_dpp v161, v20, v112 row_newbcast:6 row_mask:0xf bank_mask:0xf
    v_dot2c_f32_bf16_dpp v162, v12, v113 row_newbcast:6 row_mask:0xf bank_mask:0xf
    v_dot2c_f32_bf16_dpp v163, v20, v113 row_newbcast:6 row_mask:0xf bank_mask:0xf
    v_dot2c_f32_bf16_dpp v164, v12, v114 row_newbcast:6 row_mask:0xf bank_mask:0xf
    v_dot2c_f32_bf16_dpp v165, v20, v114 row_newbcast:6 row_mask:0xf bank_mask:0xf
    v_dot2c_f32_bf16_dpp v166, v12, v115 row_newbcast:6 row_mask:0xf bank_mask:0xf
    v_dot2c_f32_bf16_dpp v167, v20, v115 row_newbcast:6 row_mask:0xf bank_mask:0xf
    s_waitcnt vmcnt(10)
    v_dot2c_f32_bf16_dpp v160, v13, v116 row_newbcast:6 row_mask:0xf bank_mask:0xf
    v_dot2c_f32_bf16_dpp v161, v21, v116 row_newbcast:6 row_mask:0xf bank_mask:0xf
    v_dot2c_f32_bf16_dpp v162, v13, v117 row_newbcast:6 row_mask:0xf bank_mask:0xf
    v_dot2c_f32_bf16_dpp v163, v21, v117 row_newbcast:6 row_mask:0xf bank_mask:0xf
    v_dot2c_f32_bf16_dpp v164, v13, v118 row_newbcast:6 row_mask:0xf bank_mask:0xf
    v_dot2c_f32_bf16_dpp v165, v21, v118 row_newbcast:6 row_mask:0xf bank_mask:0xf
    v_dot2c_f32_bf16_dpp v166, v13, v119 row_newbcast:6 row_mask:0xf bank_mask:0xf
    v_dot2c_f32_bf16_dpp v167, v21, v119 row_newbcast:6 row_mask:0xf bank_mask:0xf
    s_waitcnt vmcnt(9)
    v_dot2c_f32_bf16_dpp v160, v14, v120 row_newbcast:6 row_mask:0xf bank_mask:0xf
    v_dot2c_f32_bf16_dpp v161, v22, v120 row_newbcast:6 row_mask:0xf bank_mask:0xf
    v_dot2c_f32_bf16_dpp v162, v14, v121 row_newbcast:6 row_mask:0xf bank_mask:0xf
    v_dot2c_f32_bf16_dpp v163, v22, v121 row_newbcast:6 row_mask:0xf bank_mask:0xf
    v_dot2c_f32_bf16_dpp v164, v14, v122 row_newbcast:6 row_mask:0xf bank_mask:0xf
    v_dot2c_f32_bf16_dpp v165, v22, v122 row_newbcast:6 row_mask:0xf bank_mask:0xf
    v_dot2c_f32_bf16_dpp v166, v14, v123 row_newbcast:6 row_mask:0xf bank_mask:0xf
    v_dot2c_f32_bf16_dpp v167, v22, v123 row_newbcast:6 row_mask:0xf bank_mask:0xf
    s_waitcnt vmcnt(8)
    v_dot2c_f32_bf16_dpp v160, v15, v124 row_newbcast:6 row_mask:0xf bank_mask:0xf
    v_dot2c_f32_bf16_dpp v161, v23, v124 row_newbcast:6 row_mask:0xf bank_mask:0xf
    v_dot2c_f32_bf16_dpp v162, v15, v125 row_newbcast:6 row_mask:0xf bank_mask:0xf
    v_dot2c_f32_bf16_dpp v163, v23, v125 row_newbcast:6 row_mask:0xf bank_mask:0xf
    v_dot2c_f32_bf16_dpp v164, v15, v126 row_newbcast:6 row_mask:0xf bank_mask:0xf
    v_dot2c_f32_bf16_dpp v165, v23, v126 row_newbcast:6 row_mask:0xf bank_mask:0xf
    v_dot2c_f32_bf16_dpp v166, v15, v127 row_newbcast:6 row_mask:0xf bank_mask:0xf
    v_dot2c_f32_bf16_dpp v167, v23, v127 row_newbcast:6 row_mask:0xf bank_mask:0xf
    s_waitcnt vmcnt(7)
    v_dot2c_f32_bf16_dpp v160, v8, v128 row_newbcast:7 row_mask:0xf bank_mask:0xf
    v_dot2c_f32_bf16_dpp v161, v16, v128 row_newbcast:7 row_mask:0xf bank_mask:0xf
    v_dot2c_f32_bf16_dpp v162, v8, v129 row_newbcast:7 row_mask:0xf bank_mask:0xf
    v_dot2c_f32_bf16_dpp v163, v16, v129 row_newbcast:7 row_mask:0xf bank_mask:0xf
    v_dot2c_f32_bf16_dpp v164, v8, v130 row_newbcast:7 row_mask:0xf bank_mask:0xf
    v_dot2c_f32_bf16_dpp v165, v16, v130 row_newbcast:7 row_mask:0xf bank_mask:0xf
    v_dot2c_f32_bf16_dpp v166, v8, v131 row_newbcast:7 row_mask:0xf bank_mask:0xf
    v_dot2c_f32_bf16_dpp v167, v16, v131 row_newbcast:7 row_mask:0xf bank_mask:0xf
    s_waitcnt vmcnt(6)
    v_dot2c_f32_bf16_dpp v160, v9, v132 row_newbcast:7 row_mask:0xf bank_mask:0xf
    v_dot2c_f32_bf16_dpp v161, v17, v132 row_newbcast:7 row_mask:0xf bank_mask:0xf
    v_dot2c_f32_bf16_dpp v162, v9, v133 row_newbcast:7 row_mask:0xf bank_mask:0xf
    v_dot2c_f32_bf16_dpp v163, v17, v133 row_newbcast:7 row_mask:0xf bank_mask:0xf
    v_dot2c_f32_bf16_dpp v164, v9, v134 row_newbcast:7 row_mask:0xf bank_mask:0xf
    v_dot2c_f32_bf16_dpp v165, v17, v134 row_newbcast:7 row_mask:0xf bank_mask:0xf
    v_dot2c_f32_bf16_dpp v166, v9, v135 row_newbcast:7 row_mask:0xf bank_mask:0xf
    v_dot2c_f32_bf16_dpp v167, v17, v135 row_newbcast:7 row_mask:0xf bank_mask:0xf
    s_waitcnt vmcnt(5)
    v_dot2c_f32_bf16_dpp v160, v10, v136 row_newbcast:7 row_mask:0xf bank_mask:0xf
    v_dot2c_f32_bf16_dpp v161, v18, v136 row_newbcast:7 row_mask:0xf bank_mask:0xf
    v_dot2c_f32_bf16_dpp v162, v10, v137 row_newbcast:7 row_mask:0xf bank_mask:0xf
    v_dot2c_f32_bf16_dpp v163, v18, v137 row_newbcast:7 row_mask:0xf bank_mask:0xf
    v_dot2c_f32_bf16_dpp v164, v10, v138 row_newbcast:7 row_mask:0xf bank_mask:0xf
    v_dot2c_f32_bf16_dpp v165, v18, v138 row_newbcast:7 row_mask:0xf bank_mask:0xf
    v_dot2c_f32_bf16_dpp v166, v10, v139 row_newbcast:7 row_mask:0xf bank_mask:0xf
    v_dot2c_f32_bf16_dpp v167, v18, v139 row_newbcast:7 row_mask:0xf bank_mask:0xf
    s_waitcnt vmcnt(4)
    v_dot2c_f32_bf16_dpp v160, v11, v140 row_newbcast:7 row_mask:0xf bank_mask:0xf
    v_dot2c_f32_bf16_dpp v161, v19, v140 row_newbcast:7 row_mask:0xf bank_mask:0xf
    v_dot2c_f32_bf16_dpp v162, v11, v141 row_newbcast:7 row_mask:0xf bank_mask:0xf
    v_dot2c_f32_bf16_dpp v163, v19, v141 row_newbcast:7 row_mask:0xf bank_mask:0xf
    v_dot2c_f32_bf16_dpp v164, v11, v142 row_newbcast:7 row_mask:0xf bank_mask:0xf
    v_dot2c_f32_bf16_dpp v165, v19, v142 row_newbcast:7 row_mask:0xf bank_mask:0xf
    v_dot2c_f32_bf16_dpp v166, v11, v143 row_newbcast:7 row_mask:0xf bank_mask:0xf
    v_dot2c_f32_bf16_dpp v167, v19, v143 row_newbcast:7 row_mask:0xf bank_mask:0xf
    s_waitcnt vmcnt(3)
    v_dot2c_f32_bf16_dpp v160, v12, v144 row_newbcast:7 row_mask:0xf bank_mask:0xf
    v_dot2c_f32_bf16_dpp v161, v20, v144 row_newbcast:7 row_mask:0xf bank_mask:0xf
    v_dot2c_f32_bf16_dpp v162, v12, v145 row_newbcast:7 row_mask:0xf bank_mask:0xf
    v_dot2c_f32_bf16_dpp v163, v20, v145 row_newbcast:7 row_mask:0xf bank_mask:0xf
    v_dot2c_f32_bf16_dpp v164, v12, v146 row_newbcast:7 row_mask:0xf bank_mask:0xf
    v_dot2c_f32_bf16_dpp v165, v20, v146 row_newbcast:7 row_mask:0xf bank_mask:0xf
    v_dot2c_f32_bf16_dpp v166, v12, v147 row_newbcast:7 row_mask:0xf bank_mask:0xf
    v_dot2c_f32_bf16_dpp v167, v20, v147 row_newbcast:7 row_mask:0xf bank_mask:0xf
    s_waitcnt vmcnt(2)
    v_dot2c_f32_bf16_dpp v160, v13, v148 row_newbcast:7 row_mask:0xf bank_mask:0xf
    v_dot2c_f32_bf16_dpp v161, v21, v148 row_newbcast:7 row_mask:0xf bank_mask:0xf
    v_dot2c_f32_bf16_dpp v162, v13, v149 row_newbcast:7 row_mask:0xf bank_mask:0xf
    v_dot2c_f32_bf16_dpp v163, v21, v149 row_newbcast:7 row_mask:0xf bank_mask:0xf
    v_dot2c_f32_bf16_dpp v164, v13, v150 row_newbcast:7 row_mask:0xf bank_mask:0xf
    v_dot2c_f32_bf16_dpp v165, v21, v150 row_newbcast:7 row_mask:0xf bank_mask:0xf
    v_dot2c_f32_bf16_dpp v166, v13, v151 row_newbcast:7 row_mask:0xf bank_mask:0xf
    v_dot2c_f32_bf16_dpp v167, v21, v151 row_newbcast:7 row_mask:0xf bank_mask:0xf
    s_waitcnt vmcnt(1)
    v_dot2c_f32_bf16_dpp v160, v14, v152 row_newbcast:7 row_mask:0xf bank_mask:0xf
    v_dot2c_f32_bf16_dpp v161, v22, v152 row_newbcast:7 row_mask:0xf bank_mask:0xf
    v_dot2c_f32_bf16_dpp v162, v14, v153 row_newbcast:7 row_mask:0xf bank_mask:0xf
    v_dot2c_f32_bf16_dpp v163, v22, v153 row_newbcast:7 row_mask:0xf bank_mask:0xf
    v_dot2c_f32_bf16_dpp v164, v14, v154 row_newbcast:7 row_mask:0xf bank_mask:0xf
    v_dot2c_f32_bf16_dpp v165, v22, v154 row_newbcast:7 row_mask:0xf bank_mask:0xf
    v_dot2c_f32_bf16_dpp v166, v14, v155 row_newbcast:7 row_mask:0xf bank_mask:0xf
    v_dot2c_f32_bf16_dpp v167, v22, v155 row_newbcast:7 row_mask:0xf bank_mask:0xf
    s_waitcnt vmcnt(0)
    v_dot2c_f32_bf16_dpp v160, v15, v156 row_newbcast:7 row_mask:0xf bank_mask:0xf
    v_dot2c_f32_bf16_dpp v161, v23, v156 row_newbcast:7 row_mask:0xf bank_mask:0xf
    v_dot2c_f32_bf16_dpp v162, v15, v157 row_newbcast:7 row_mask:0xf bank_mask:0xf
    v_dot2c_f32_bf16_dpp v163, v23, v157 row_newbcast:7 row_mask:0xf bank_mask:0xf
    v_dot2c_f32_bf16_dpp v164, v15, v158 row_newbcast:7 row_mask:0xf bank_mask:0xf
    v_dot2c_f32_bf16_dpp v165, v23, v158 row_newbcast:7 row_mask:0xf bank_mask:0xf
    v_dot2c_f32_bf16_dpp v166, v15, v159 row_newbcast:7 row_mask:0xf bank_mask:0xf
    v_dot2c_f32_bf16_dpp v167, v23, v159 row_newbcast:7 row_mask:0xf bank_mask:0xf
    s_lshl_b32 s89, s82, 5
    s_add_u32 s89, s89, s81
    s_lshl_b32 s89, s89, 11
    s_add_u32 s89, s89, 0xA0000
    v_mul_f32 v160, v160, v6
    v_mul_f32 v161, v161, v6
    v_mul_f32 v162, v162, v6
    v_mul_f32 v163, v163, v6
    v_mul_f32 v164, v164, v6
    v_mul_f32 v165, v165, v6
    v_mul_f32 v166, v166, v6
    v_mul_f32 v167, v167, v6
    buffer_store_dwordx4 v[160:163], v1, s[76:79], s89 offen sc1
    buffer_store_dwordx4 v[164:167], v1, s[76:79], s89 offen offset:1024 sc1
    s_lshl_b32 s89, s82, 6
    v_mov_b32 v7, 1
    s_mov_b64 exec, 1
    s_waitcnt vmcnt(0)
    buffer_atomic_add v7, off, s[72:75], s89 offset:12 sc0
    s_mov_b64 exec, -1
    s_waitcnt vmcnt(0)
    v_readfirstlane_b32 s89, v7
    s_cmp_lg_u32 s89, 27
    s_cbranch_scc1 L_ffn_fin
    s_lshl_b32 s84, s82, 16
    s_add_u32 s84, s84, 0xA0000
    s_add_u32 s85, s84, 4096
    s_add_u32 s86, s84, 8192
    s_add_u32 s87, s84, 12288
    buffer_load_dwordx4 v[32:35], v1, s[76:79], s84 offen offset:0 sc1
    buffer_load_dwordx4 v[36:39], v1, s[76:79], s84 offen offset:1024 sc1
    buffer_load_dwordx4 v[40:43], v1, s[76:79], s84 offen offset:2048 sc1
    buffer_load_dwordx4 v[44:47], v1, s[76:79], s84 offen offset:3072 sc1
    buffer_load_dwordx4 v[48:51], v1, s[76:79], s85 offen offset:0 sc1
    buffer_load_dwordx4 v[52:55], v1, s[76:79], s85 offen offset:1024 sc1
    buffer_load_dwordx4 v[56:59], v1, s[76:79], s85 offen offset:2048 sc1
    buffer_load_dwordx4 v[60:63], v1, s[76:79], s85 offen offset:3072 sc1
    buffer_load_dwordx4 v[64:67], v1, s[76:79], s86 offen offset:0 sc1
    buffer_load_dwordx4 v[68:71], v1, s[76:79], s86 offen offset:1024 sc1
    buffer_load_dwordx4 v[72:75], v1, s[76:79], s86 offen offset:2048 sc1
    buffer_load_dwordx4 v[76:79], v1, s[76:79], s86 offen offset:3072 sc1
    buffer_load_dwordx4 v[80:83], v1, s[76:79], s87 offen offset:0 sc1
    buffer_load_dwordx4 v[84:87], v1, s[76:79], s87 offen offset:1024 sc1
    buffer_load_dwordx4 v[88:91], v1, s[76:79], s87 offen offset:2048 sc1
    buffer_load_dwordx4 v[92:95], v1, s[76:79], s87 offen offset:3072 sc1
    s_add_u32 s84, s84, 16384
    s_add_u32 s85, s85, 16384
    s_add_u32 s86, s86, 16384
    s_add_u32 s87, s87, 16384
    buffer_load_dwordx4 v[96:99], v1, s[76:79], s84 offen offset:0 sc1
    buffer_load_dwordx4 v[100:103], v1, s[76:79], s84 offen offset:1024 sc1
    buffer_load_dwordx4 v[104:107], v1, s[76:79], s84 offen offset:2048 sc1
    buffer_load_dwordx4 v[108:111], v1, s[76:79], s84 offen offset:3072 sc1
    buffer_load_dwordx4 v[112:115], v1, s[76:79], s85 offen offset:0 sc1
    buffer_load_dwordx4 v[116:119], v1, s[76:79], s85 offen offset:1024 sc1
    buffer_load_dwordx4 v[120:123], v1, s[76:79], s85 offen offset:2048 sc1
    buffer_load_dwordx4 v[124:127], v1, s[76:79], s85 offen offset:3072 sc1
    buffer_load_dwordx4 v[128:131], v1, s[76:79], s86 offen offset:0 sc1
    buffer_load_dwordx4 v[132:135], v1, s[76:79], s86 offen offset:1024 sc1
    buffer_load_dwordx4 v[136:139], v1, s[76:79], s86 offen offset:2048 sc1
    buffer_load_dwordx4 v[140:143], v1, s[76:79], s86 offen offset:3072 sc1
    buffer_load_dwordx4 v[144:147], v1, s[76:79], s87 offen offset:0 sc1
    buffer_load_dwordx4 v[148:151], v1, s[76:79], s87 offen offset:1024 sc1
    buffer_load_dwordx4 v[152:155], v1, s[76:79], s87 offen offset:2048 sc1
    buffer_load_dwordx4 v[156:159], v1, s[76:79], s87 offen offset:3072 sc1
    s_add_u32 s84, s84, 16384
    s_add_u32 s85, s85, 16384
    s_add_u32 s86, s86, 16384
    s_add_u32 s87, s87, 16384
    v_mov_b32 v160, 0
    v_mov_b32 v161, 0
    v_mov_b32 v162, 0
    v_mov_b32 v163, 0
    v_mov_b32 v164, 0
    v_mov_b32 v165, 0
    v_mov_b32 v166, 0
    v_mov_b32 v167, 0
    s_waitcnt vmcnt(31)
    v_add_f32 v160, v160, v32
    v_add_f32 v161, v161, v33
    v_add_f32 v162, v162, v34
    v_add_f32 v163, v163, v35
    buffer_load_dwordx4 v[32:35], v1, s[76:79], s84 offen offset:0 sc1
    s_waitcnt vmcnt(31)
    v_add_f32 v164, v164, v36
    v_add_f32 v165, v165, v37
    v_add_f32 v166, v166, v38
    v_add_f32 v167, v167, v39
    buffer_load_dwordx4 v[36:39], v1, s[76:79], s84 offen offset:1024 sc1
    s_waitcnt vmcnt(31)
    v_add_f32 v160, v160, v40
    v_add_f32 v161, v161, v41
    v_add_f32 v162, v162, v42
    v_add_f32 v163, v163, v43
    buffer_load_dwordx4 v[40:43], v1, s[76:79], s84 offen offset:2048 sc1
    s_waitcnt vmcnt(31)
    v_add_f32 v164, v164, v44
    v_add_f32 v165, v165, v45
    v_add_f32 v166, v166, v46
    v_add_f32 v167, v167, v47
    buffer_load_dwordx4 v[44:47], v1, s[76:79], s84 offen offset:3072 sc1
    s_waitcnt vmcnt(31)
    v_add_f32 v160, v160, v48
    v_add_f32 v161, v161, v49
    v_add_f32 v162, v162, v50
    v_add_f32 v163, v163, v51
    buffer_load_dwordx4 v[48:51], v1, s[76:79], s85 offen offset:0 sc1
    s_waitcnt vmcnt(31)
    v_add_f32 v164, v164, v52
    v_add_f32 v165, v165, v53
    v_add_f32 v166, v166, v54
    v_add_f32 v167, v167, v55
    buffer_load_dwordx4 v[52:55], v1, s[76:79], s85 offen offset:1024 sc1
    s_waitcnt vmcnt(31)
    v_add_f32 v160, v160, v56
    v_add_f32 v161, v161, v57
    v_add_f32 v162, v162, v58
    v_add_f32 v163, v163, v59
    buffer_load_dwordx4 v[56:59], v1, s[76:79], s85 offen offset:2048 sc1
    s_waitcnt vmcnt(31)
    v_add_f32 v164, v164, v60
    v_add_f32 v165, v165, v61
    v_add_f32 v166, v166, v62
    v_add_f32 v167, v167, v63
    buffer_load_dwordx4 v[60:63], v1, s[76:79], s85 offen offset:3072 sc1
    s_waitcnt vmcnt(31)
    v_add_f32 v160, v160, v64
    v_add_f32 v161, v161, v65
    v_add_f32 v162, v162, v66
    v_add_f32 v163, v163, v67
    buffer_load_dwordx4 v[64:67], v1, s[76:79], s86 offen offset:0 sc1
    s_waitcnt vmcnt(31)
    v_add_f32 v164, v164, v68
    v_add_f32 v165, v165, v69
    v_add_f32 v166, v166, v70
    v_add_f32 v167, v167, v71
    buffer_load_dwordx4 v[68:71], v1, s[76:79], s86 offen offset:1024 sc1
    s_waitcnt vmcnt(31)
    v_add_f32 v160, v160, v72
    v_add_f32 v161, v161, v73
    v_add_f32 v162, v162, v74
    v_add_f32 v163, v163, v75
    buffer_load_dwordx4 v[72:75], v1, s[76:79], s86 offen offset:2048 sc1
    s_waitcnt vmcnt(31)
    v_add_f32 v164, v164, v76
    v_add_f32 v165, v165, v77
    v_add_f32 v166, v166, v78
    v_add_f32 v167, v167, v79
    buffer_load_dwordx4 v[76:79], v1, s[76:79], s86 offen offset:3072 sc1
    s_waitcnt vmcnt(31)
    v_add_f32 v160, v160, v80
    v_add_f32 v161, v161, v81
    v_add_f32 v162, v162, v82
    v_add_f32 v163, v163, v83
    buffer_load_dwordx4 v[80:83], v1, s[76:79], s87 offen offset:0 sc1
    s_waitcnt vmcnt(31)
    v_add_f32 v164, v164, v84
    v_add_f32 v165, v165, v85
    v_add_f32 v166, v166, v86
    v_add_f32 v167, v167, v87
    buffer_load_dwordx4 v[84:87], v1, s[76:79], s87 offen offset:1024 sc1
    s_waitcnt vmcnt(31)
    v_add_f32 v160, v160, v88
    v_add_f32 v161, v161, v89
    v_add_f32 v162, v162, v90
    v_add_f32 v163, v163, v91
    buffer_load_dwordx4 v[88:91], v1, s[76:79], s87 offen offset:2048 sc1
    s_waitcnt vmcnt(31)
    v_add_f32 v164, v164, v92
    v_add_f32 v165, v165, v93
    v_add_f32 v166, v166, v94
    v_add_f32 v167, v167, v95
    buffer_load_dwordx4 v[92:95], v1, s[76:79], s87 offen offset:3072 sc1
    s_add_u32 s84, s84, 16384
    s_add_u32 s85, s85, 16384
    s_add_u32 s86, s86, 16384
    s_add_u32 s87, s87, 16384
    s_waitcnt vmcnt(31)
    v_add_f32 v160, v160, v96
    v_add_f32 v161, v161, v97
    v_add_f32 v162, v162, v98
    v_add_f32 v163, v163, v99
    buffer_load_dwordx4 v[96:99], v1, s[76:79], s84 offen offset:0 sc1
    s_waitcnt vmcnt(31)
    v_add_f32 v164, v164, v100
    v_add_f32 v165, v165, v101
    v_add_f32 v166, v166, v102
    v_add_f32 v167, v167, v103
    buffer_load_dwordx4 v[100:103], v1, s[76:79], s84 offen offset:1024 sc1
    s_waitcnt vmcnt(31)
    v_add_f32 v160, v160, v104
    v_add_f32 v161, v161, v105
    v_add_f32 v162, v162, v106
    v_add_f32 v163, v163, v107
    buffer_load_dwordx4 v[104:107], v1, s[76:79], s84 offen offset:2048 sc1
    s_waitcnt vmcnt(31)
    v_add_f32 v164, v164, v108
    v_add_f32 v165, v165, v109
    v_add_f32 v166, v166, v110
    v_add_f32 v167, v167, v111
    buffer_load_dwordx4 v[108:111], v1, s[76:79], s84 offen offset:3072 sc1
    s_waitcnt vmcnt(31)
    v_add_f32 v160, v160, v112
    v_add_f32 v161, v161, v113
    v_add_f32 v162, v162, v114
    v_add_f32 v163, v163, v115
    buffer_load_dwordx4 v[112:115], v1, s[76:79], s85 offen offset:0 sc1
    s_waitcnt vmcnt(31)
    v_add_f32 v164, v164, v116
    v_add_f32 v165, v165, v117
    v_add_f32 v166, v166, v118
    v_add_f32 v167, v167, v119
    buffer_load_dwordx4 v[116:119], v1, s[76:79], s85 offen offset:1024 sc1
    s_waitcnt vmcnt(31)
    v_add_f32 v160, v160, v120
    v_add_f32 v161, v161, v121
    v_add_f32 v162, v162, v122
    v_add_f32 v163, v163, v123
    buffer_load_dwordx4 v[120:123], v1, s[76:79], s85 offen offset:2048 sc1
    s_waitcnt vmcnt(31)
    v_add_f32 v164, v164, v124
    v_add_f32 v165, v165, v125
    v_add_f32 v166, v166, v126
    v_add_f32 v167, v167, v127
    buffer_load_dwordx4 v[124:127], v1, s[76:79], s85 offen offset:3072 sc1
    s_waitcnt vmcnt(31)
    v_add_f32 v160, v160, v128
    v_add_f32 v161, v161, v129
    v_add_f32 v162, v162, v130
    v_add_f32 v163, v163, v131
    s_waitcnt vmcnt(30)
    v_add_f32 v164, v164, v132
    v_add_f32 v165, v165, v133
    v_add_f32 v166, v166, v134
    v_add_f32 v167, v167, v135
    s_waitcnt vmcnt(29)
    v_add_f32 v160, v160, v136
    v_add_f32 v161, v161, v137
    v_add_f32 v162, v162, v138
    v_add_f32 v163, v163, v139
    s_waitcnt vmcnt(28)
    v_add_f32 v164, v164, v140
    v_add_f32 v165, v165, v141
    v_add_f32 v166, v166, v142
    v_add_f32 v167, v167, v143
    s_waitcnt vmcnt(27)
    v_add_f32 v160, v160, v144
    v_add_f32 v161, v161, v145
    v_add_f32 v162, v162, v146
    v_add_f32 v163, v163, v147
    s_waitcnt vmcnt(26)
    v_add_f32 v164, v164, v148
    v_add_f32 v165, v165, v149
    v_add_f32 v166, v166, v150
    v_add_f32 v167, v167, v151
    s_waitcnt vmcnt(25)
    v_add_f32 v160, v160, v152
    v_add_f32 v161, v161, v153
    v_add_f32 v162, v162, v154
    v_add_f32 v163, v163, v155
    s_waitcnt vmcnt(24)
    v_add_f32 v164, v164, v156
    v_add_f32 v165, v165, v157
    v_add_f32 v166, v166, v158
    v_add_f32 v167, v167, v159
    s_waitcnt vmcnt(23)
    v_add_f32 v160, v160, v32
    v_add_f32 v161, v161, v33
    v_add_f32 v162, v162, v34
    v_add_f32 v163, v163, v35
    s_waitcnt vmcnt(22)
    v_add_f32 v164, v164, v36
    v_add_f32 v165, v165, v37
    v_add_f32 v166, v166, v38
    v_add_f32 v167, v167, v39
    s_waitcnt vmcnt(21)
    v_add_f32 v160, v160, v40
    v_add_f32 v161, v161, v41
    v_add_f32 v162, v162, v42
    v_add_f32 v163, v163, v43
    s_waitcnt vmcnt(20)
    v_add_f32 v164, v164, v44
    v_add_f32 v165, v165, v45
    v_add_f32 v166, v166, v46
    v_add_f32 v167, v167, v47
    s_waitcnt vmcnt(19)
    v_add_f32 v160, v160, v48
    v_add_f32 v161, v161, v49
    v_add_f32 v162, v162, v50
    v_add_f32 v163, v163, v51
    s_waitcnt vmcnt(18)
    v_add_f32 v164, v164, v52
    v_add_f32 v165, v165, v53
    v_add_f32 v166, v166, v54
    v_add_f32 v167, v167, v55
    s_waitcnt vmcnt(17)
    v_add_f32 v160, v160, v56
    v_add_f32 v161, v161, v57
    v_add_f32 v162, v162, v58
    v_add_f32 v163, v163, v59
    s_waitcnt vmcnt(16)
    v_add_f32 v164, v164, v60
    v_add_f32 v165, v165, v61
    v_add_f32 v166, v166, v62
    v_add_f32 v167, v167, v63
    s_waitcnt vmcnt(15)
    v_add_f32 v160, v160, v64
    v_add_f32 v161, v161, v65
    v_add_f32 v162, v162, v66
    v_add_f32 v163, v163, v67
    s_waitcnt vmcnt(14)
    v_add_f32 v164, v164, v68
    v_add_f32 v165, v165, v69
    v_add_f32 v166, v166, v70
    v_add_f32 v167, v167, v71
    s_waitcnt vmcnt(13)
    v_add_f32 v160, v160, v72
    v_add_f32 v161, v161, v73
    v_add_f32 v162, v162, v74
    v_add_f32 v163, v163, v75
    s_waitcnt vmcnt(12)
    v_add_f32 v164, v164, v76
    v_add_f32 v165, v165, v77
    v_add_f32 v166, v166, v78
    v_add_f32 v167, v167, v79
    s_waitcnt vmcnt(11)
    v_add_f32 v160, v160, v80
    v_add_f32 v161, v161, v81
    v_add_f32 v162, v162, v82
    v_add_f32 v163, v163, v83
    s_waitcnt vmcnt(10)
    v_add_f32 v164, v164, v84
    v_add_f32 v165, v165, v85
    v_add_f32 v166, v166, v86
    v_add_f32 v167, v167, v87
    s_waitcnt vmcnt(9)
    v_add_f32 v160, v160, v88
    v_add_f32 v161, v161, v89
    v_add_f32 v162, v162, v90
    v_add_f32 v163, v163, v91
    s_waitcnt vmcnt(8)
    v_add_f32 v164, v164, v92
    v_add_f32 v165, v165, v93
    v_add_f32 v166, v166, v94
    v_add_f32 v167, v167, v95
    s_waitcnt vmcnt(7)
    v_add_f32 v160, v160, v96
    v_add_f32 v161, v161, v97
    v_add_f32 v162, v162, v98
    v_add_f32 v163, v163, v99
    s_waitcnt vmcnt(6)
    v_add_f32 v164, v164, v100
    v_add_f32 v165, v165, v101
    v_add_f32 v166, v166, v102
    v_add_f32 v167, v167, v103
    s_waitcnt vmcnt(5)
    v_add_f32 v160, v160, v104
    v_add_f32 v161, v161, v105
    v_add_f32 v162, v162, v106
    v_add_f32 v163, v163, v107
    s_waitcnt vmcnt(4)
    v_add_f32 v164, v164, v108
    v_add_f32 v165, v165, v109
    v_add_f32 v166, v166, v110
    v_add_f32 v167, v167, v111
    s_waitcnt vmcnt(3)
    v_add_f32 v160, v160, v112
    v_add_f32 v161, v161, v113
    v_add_f32 v162, v162, v114
    v_add_f32 v163, v163, v115
    s_waitcnt vmcnt(2)
    v_add_f32 v164, v164, v116
    v_add_f32 v165, v165, v117
    v_add_f32 v166, v166, v118
    v_add_f32 v167, v167, v119
    s_waitcnt vmcnt(1)
    v_add_f32 v160, v160, v120
    v_add_f32 v161, v161, v121
    v_add_f32 v162, v162, v122
    v_add_f32 v163, v163, v123
    s_waitcnt vmcnt(0)
    v_add_f32 v164, v164, v124
    v_add_f32 v165, v165, v125
    v_add_f32 v166, v166, v126
    v_add_f32 v167, v167, v127
    s_lshl_b32 s89, s82, 11
    s_add_u32 s89, s89, 0xE0000
    buffer_store_dwordx4 v[160:163], v1, s[76:79], s89 offen sc1
    buffer_store_dwordx4 v[164:167], v1, s[76:79], s89 offen offset:1024 sc1
L_ffn_fin:
    s_waitcnt vmcnt(0) lgkmcnt(0)
L_end:
    s_endpgm
.section .rodata,"a"
.p2align 6
.amdhsa_kernel gated_mix__mha_block_cached__glu_gated_swiglu__decode_kernel
  .amdhsa_next_free_vgpr 168
  .amdhsa_next_free_sgpr 102
  .amdhsa_accum_offset 168
  .amdhsa_group_segment_fixed_size 0
  .amdhsa_kernarg_size 104
  .amdhsa_user_sgpr_count 2
  .amdhsa_user_sgpr_kernarg_segment_ptr 1
  .amdhsa_system_sgpr_workgroup_id_x 1
.end_amdhsa_kernel
```
